```python
import torch

def _softmax(x, axis=-1):
    return torch.softmax(x, dim=axis)
def _gelu(x):
    return torch.nn.functional.gelu(x, approximate="tanh")
def _silu(x):
    return torch.nn.functional.silu(x)
def _sigmoid(x):
    return torch.sigmoid(x)
def _layernorm(x, axis=-1, eps=1e-5):
    m = x.mean(dim=axis, keepdim=True)
    v = x.var(dim=axis, keepdim=True, unbiased=False)
    return (x - m) / torch.sqrt(v + eps)
def _scatter_add(tgt, idx, src, axis=0):
    return tgt.clone().index_add_(axis, idx, src)
def _segment_sum(src, seg, n):
    out = torch.zeros((n,) + src.shape[1:], dtype=src.dtype)
    return out.index_add_(0, seg, src)
def _pad(x, pw):
    flat = tuple(v for pair in reversed(pw) for v in pair)
    return torch.nn.functional.pad(x, flat)

kernel_name = 'standalone__softmax_full_mha__prompt'

def setup_inputs():

    _w = (lambda a: (lambda t: t.to(torch.bfloat16) if t.is_floating_point() else t)(torch.as_tensor(a)))
    B, S, D = 1, 2048, 1024
    return {
        "x": _w((lambda *s: torch.randn(*s, dtype=torch.bfloat16) * 0.2)(B, S, D)),
        "wqkv": _w((lambda *s: torch.randn(*s, dtype=torch.bfloat16) * 0.2)(D, 3 * D)),
        "wo": _w((lambda *s: torch.randn(*s, dtype=torch.bfloat16) * 0.05)(D, D)),
    }

def reference(x, wqkv, wo):
    B, S, D = x.shape
    H = 32; Dh = D // H
    qkv = (lambda x, *d: x.permute(*d))((x @ wqkv).reshape(B, S, 3, H, Dh), 2, 0, 3, 1, 4)
    q, k, v = qkv[0], qkv[1], qkv[2]
    scale = Dh ** -0.5
    scores = torch.einsum("bhqd,bhkd->bhqk", q, k) * scale
    p = _softmax(scores, axis=-1)
    o = torch.einsum("bhqk,bhkd->bhqd", p, v)
    return (lambda x, *d: x.permute(*d))(o, 0, 2, 1, 3).reshape(B, S, D) @ wo
```

```asm
; @launch grid=(256,1,1) block=(512,1,1) lds=163840
.amdgcn_target "amdgcn-amd-amdhsa--gfx950"
.text
.globl standalone__softmax_full_mha__prompt_kernel
.p2align 8
.type standalone__softmax_full_mha__prompt_kernel,@function
standalone__softmax_full_mha__prompt_kernel:
    s_cmp_ge_u32 s2, 256
    s_cbranch_scc1 L_end
    s_load_dwordx4 s[4:7], s[0:1], 0
    s_load_dwordx2 s[8:9], s[0:1], 40
    s_load_dwordx4 s[40:43], s[0:1], 16
    s_load_dwordx2 s[44:45], s[0:1], 32
    s_and_b32 s12, s2, 7
    s_lshr_b32 s11, s2, 3
    s_mov_b32 s13, 0
    s_lshl_b32 s10, s12, 1
    s_and_b32 s16, s11, 1
    s_add_u32 s10, s10, s16
    s_lshr_b32 s11, s11, 1
    v_lshrrev_b32 v1, 6, v0
    v_and_b32 v2, 63, v0
    v_lshlrev_b32 v3, 4, v2
    v_readfirstlane_b32 s14, v1
    s_waitcnt lgkmcnt(0)
    s_mov_b32 s24, s8
    s_mov_b32 s25, s9
    s_mov_b32 s26, 13631488
    s_mov_b32 s27, 0x20000
    s_cmp_lt_u32 s14, 4
    s_cbranch_scc1 L_g1_compute
    s_sub_u32 s15, s14, 4
    s_lshl_b32 s16, s11, 18
    s_sub_u32 s17, 0x400000, s16
    s_add_u32 s28, s4, s16
    s_addc_u32 s29, s5, 0
    s_mov_b32 s30, s17
    s_mov_b32 s31, 0x20000
    s_lshl_b32 s16, s10, 7
    s_sub_u32 s17, 0x600000, s16
    s_add_u32 s32, s6, s16
    s_addc_u32 s33, s7, 0
    s_mov_b32 s34, s17
    s_mov_b32 s35, 0x20000
    v_lshrrev_b32 v4, 3, v2
    v_lshlrev_b32 v5, 11, v4
    v_and_b32 v6, 7, v2
    v_lshrrev_b32 v7, 4, v2
    v_xor_b32 v8, v6, v7
    v_lshlrev_b32 v8, 4, v8
    v_add_u32 v5, v5, v8
    s_lshl_b32 s16, s15, 16
    v_add_u32 v10, s16, v5
    v_xor_b32 v11, 64, v10
    v_mul_u32_u24 v5, 6144, v4
    v_and_b32 v7, 1, v7
    v_lshlrev_b32 v7, 2, v7
    v_xor_b32 v8, v6, v7
    v_lshlrev_b32 v8, 4, v8
    v_add_u32 v5, v5, v8
    s_mul_i32 s16, s15, 98304
    v_add_u32 v12, s16, v5
    s_lshl_b32 s18, s15, 12
    s_lshl_b32 s19, s15, 11
    s_add_u32 s19, s19, 16384
    s_mov_b32 s20, s13
    s_mov_b32 s36, 0
    s_lshl_b32 s21, s20, 7
    s_mul_i32 s22, s20, 393216
    s_add_u32 s37, s36, s18
    s_add_u32 s39, s36, s19
    s_add_u32 m0, s37, 0
    s_add_u32 s38, s21, 0
    buffer_load_dwordx4 v10, s[28:31], s38 offen lds
    s_add_u32 m0, s37, 1024
    s_add_u32 s38, s21, 16384
    buffer_load_dwordx4 v11, s[28:31], s38 offen lds
    s_add_u32 m0, s37, 2048
    s_add_u32 s38, s21, 32768
    buffer_load_dwordx4 v10, s[28:31], s38 offen lds
    s_add_u32 m0, s37, 3072
    s_add_u32 s38, s21, 49152
    buffer_load_dwordx4 v11, s[28:31], s38 offen lds
    s_add_u32 m0, s39, 0
    s_add_u32 s38, s22, 0
    buffer_load_dwordx4 v12, s[32:35], s38 offen lds
    s_add_u32 m0, s39, 1024
    s_add_u32 s38, s22, 49152
    buffer_load_dwordx4 v12, s[32:35], s38 offen lds
    s_add_u32 m0, s39, 8192
    s_add_u32 s38, s22, 2048
    buffer_load_dwordx4 v12, s[32:35], s38 offen lds
    s_add_u32 m0, s39, 9216
    s_add_u32 s38, s22, 51200
    buffer_load_dwordx4 v12, s[32:35], s38 offen lds
    s_add_u32 m0, s39, 16384
    s_add_u32 s38, s22, 4096
    buffer_load_dwordx4 v12, s[32:35], s38 offen lds
    s_add_u32 m0, s39, 17408
    s_add_u32 s38, s22, 53248
    buffer_load_dwordx4 v12, s[32:35], s38 offen lds
    s_add_u32 s20, s20, 1
    s_and_b32 s20, s20, 15
    s_add_u32 s36, s36, 40960
    s_cmp_eq_u32 s36, 163840
    s_cselect_b32 s36, 0, s36
    s_lshl_b32 s21, s20, 7
    s_mul_i32 s22, s20, 393216
    s_add_u32 s37, s36, s18
    s_add_u32 s39, s36, s19
    s_add_u32 m0, s37, 0
    s_add_u32 s38, s21, 0
    buffer_load_dwordx4 v10, s[28:31], s38 offen lds
    s_add_u32 m0, s37, 1024
    s_add_u32 s38, s21, 16384
    buffer_load_dwordx4 v11, s[28:31], s38 offen lds
    s_add_u32 m0, s37, 2048
    s_add_u32 s38, s21, 32768
    buffer_load_dwordx4 v10, s[28:31], s38 offen lds
    s_add_u32 m0, s37, 3072
    s_add_u32 s38, s21, 49152
    buffer_load_dwordx4 v11, s[28:31], s38 offen lds
    s_add_u32 m0, s39, 0
    s_add_u32 s38, s22, 0
    buffer_load_dwordx4 v12, s[32:35], s38 offen lds
    s_add_u32 m0, s39, 1024
    s_add_u32 s38, s22, 49152
    buffer_load_dwordx4 v12, s[32:35], s38 offen lds
    s_add_u32 m0, s39, 8192
    s_add_u32 s38, s22, 2048
    buffer_load_dwordx4 v12, s[32:35], s38 offen lds
    s_add_u32 m0, s39, 9216
    s_add_u32 s38, s22, 51200
    buffer_load_dwordx4 v12, s[32:35], s38 offen lds
    s_add_u32 m0, s39, 16384
    s_add_u32 s38, s22, 4096
    buffer_load_dwordx4 v12, s[32:35], s38 offen lds
    s_add_u32 m0, s39, 17408
    s_add_u32 s38, s22, 53248
    buffer_load_dwordx4 v12, s[32:35], s38 offen lds
    s_add_u32 s20, s20, 1
    s_and_b32 s20, s20, 15
    s_add_u32 s36, s36, 40960
    s_cmp_eq_u32 s36, 163840
    s_cselect_b32 s36, 0, s36
    s_waitcnt vmcnt(10)
    s_barrier
    s_lshl_b32 s21, s20, 7
    s_mul_i32 s22, s20, 393216
    s_add_u32 s37, s36, s18
    s_add_u32 s39, s36, s19
    s_add_u32 m0, s37, 0
    s_add_u32 s38, s21, 0
    buffer_load_dwordx4 v10, s[28:31], s38 offen lds
    s_add_u32 m0, s37, 1024
    s_add_u32 s38, s21, 16384
    buffer_load_dwordx4 v11, s[28:31], s38 offen lds
    s_add_u32 m0, s37, 2048
    s_add_u32 s38, s21, 32768
    buffer_load_dwordx4 v10, s[28:31], s38 offen lds
    s_add_u32 m0, s37, 3072
    s_add_u32 s38, s21, 49152
    buffer_load_dwordx4 v11, s[28:31], s38 offen lds
    s_add_u32 m0, s39, 0
    s_add_u32 s38, s22, 0
    buffer_load_dwordx4 v12, s[32:35], s38 offen lds
    s_add_u32 m0, s39, 1024
    s_add_u32 s38, s22, 49152
    buffer_load_dwordx4 v12, s[32:35], s38 offen lds
    s_add_u32 m0, s39, 8192
    s_add_u32 s38, s22, 2048
    buffer_load_dwordx4 v12, s[32:35], s38 offen lds
    s_add_u32 m0, s39, 9216
    s_add_u32 s38, s22, 51200
    buffer_load_dwordx4 v12, s[32:35], s38 offen lds
    s_add_u32 m0, s39, 16384
    s_add_u32 s38, s22, 4096
    buffer_load_dwordx4 v12, s[32:35], s38 offen lds
    s_add_u32 m0, s39, 17408
    s_add_u32 s38, s22, 53248
    buffer_load_dwordx4 v12, s[32:35], s38 offen lds
    s_add_u32 s20, s20, 1
    s_and_b32 s20, s20, 15
    s_add_u32 s36, s36, 40960
    s_cmp_eq_u32 s36, 163840
    s_cselect_b32 s36, 0, s36
    s_mov_b32 s23, 0
L_g1_ldloop:
    s_waitcnt vmcnt(10)
    s_barrier
    s_lshl_b32 s21, s20, 7
    s_mul_i32 s22, s20, 393216
    s_add_u32 s37, s36, s18
    s_add_u32 s39, s36, s19
    s_add_u32 m0, s37, 0
    s_add_u32 s38, s21, 0
    buffer_load_dwordx4 v10, s[28:31], s38 offen lds
    s_add_u32 m0, s37, 1024
    s_add_u32 s38, s21, 16384
    buffer_load_dwordx4 v11, s[28:31], s38 offen lds
    s_add_u32 m0, s37, 2048
    s_add_u32 s38, s21, 32768
    buffer_load_dwordx4 v10, s[28:31], s38 offen lds
    s_add_u32 m0, s37, 3072
    s_add_u32 s38, s21, 49152
    buffer_load_dwordx4 v11, s[28:31], s38 offen lds
    s_add_u32 m0, s39, 0
    s_add_u32 s38, s22, 0
    buffer_load_dwordx4 v12, s[32:35], s38 offen lds
    s_add_u32 m0, s39, 1024
    s_add_u32 s38, s22, 49152
    buffer_load_dwordx4 v12, s[32:35], s38 offen lds
    s_add_u32 m0, s39, 8192
    s_add_u32 s38, s22, 2048
    buffer_load_dwordx4 v12, s[32:35], s38 offen lds
    s_add_u32 m0, s39, 9216
    s_add_u32 s38, s22, 51200
    buffer_load_dwordx4 v12, s[32:35], s38 offen lds
    s_add_u32 m0, s39, 16384
    s_add_u32 s38, s22, 4096
    buffer_load_dwordx4 v12, s[32:35], s38 offen lds
    s_add_u32 m0, s39, 17408
    s_add_u32 s38, s22, 53248
    buffer_load_dwordx4 v12, s[32:35], s38 offen lds
    s_add_u32 s20, s20, 1
    s_and_b32 s20, s20, 15
    s_add_u32 s36, s36, 40960
    s_cmp_eq_u32 s36, 163840
    s_cselect_b32 s36, 0, s36
    s_add_u32 s23, s23, 1
    s_cmp_lt_u32 s23, 13
    s_cbranch_scc1 L_g1_ldloop
    s_waitcnt vmcnt(10)
    s_barrier
    s_waitcnt vmcnt(0)
    s_barrier
    s_waitcnt vmcnt(0)
    s_barrier
    s_lshr_b32 s50, s14, 2
    s_and_b32 s51, s14, 3
    s_lshl_b32 s52, s50, 12
    v_add_u32 v229, s52, v3
    v_add_u32 v230, 65536, v229
    v_and_b32 v4, 6, v2
    v_mov_b32 v5, 0x3f803f80
    v_cmp_eq_u32 vcc, 0, v4
    s_lshl_b32 s52, s51, 12
    v_mov_b32 v231, 1
    v_cndmask_b32 v224, 0, v5, vcc
    v_cndmask_b32 v225, 0, v5, vcc
    v_cmp_eq_u32 vcc, 4, v4
    v_add_u32 v235, s52, v3
    v_add_u32 v236, s52, v3
    v_cndmask_b32 v226, 0, v5, vcc
    v_cndmask_b32 v227, 0, v5, vcc
    v_and_b32 v4, 1, v2
    v_mov_b32 v5, 0x44444444
    v_mov_b32 v7, 0xeeeeeeee
    v_cmp_eq_u32 vcc, 0, v4
    v_add_u32 v237, s52, v3
    v_add_u32 v238, s52, v3
    v_cndmask_b32 v228, v7, v5, vcc
    s_lshl_b32 s52, s50, 2
    s_add_u32 s52, s52, 147520
    v_mov_b32 v233, s52
    s_lshl_b32 s52, s14, 8
    s_add_u32 s52, s52, 148480
    v_lshlrev_b32 v4, 2, v2
    v_add_u32 v232, s52, v4
    v_cmp_eq_u32 vcc, 0, v2
    s_lshl_b32 s52, s10, 13
    s_add_u32 s52, s52, 12582912
    v_cndmask_b32 v232, v232, v233, vcc
    v_lshlrev_b32 v239, 7, v2
    v_add_u32 v239, s52, v239
    s_branch L_g1_done
L_g1_compute:
    s_cmp_eq_u32 s14, 3
    s_cbranch_scc1 L_qpf_setx
    v_min_u32 v14, 47, v2
    s_and_b32 s16, s11, 15
    s_mul_i32 s16, s16, 48
    s_add_u32 s16, s16, 0
    v_add_u32 v14, s16, v14
    s_mov_b32 s17, 0x5556
    v_mul_u32_u24 v12, s17, v14
    v_lshrrev_b32 v12, 16, v12
    v_mul_u32_u24 v13, 3, v12
    v_sub_u32 v13, v14, v13
    v_mul_u32_u24 v14, 6144, v12
    v_lshlrev_b32 v13, 11, v13
    v_add_u32 v14, v14, v13
    s_lshl_b32 s16, s10, 7
    v_add_u32 v14, s16, v14
    v_mov_b32 v15, v14
    s_branch L_qpf_set
L_qpf_setx:
    v_lshrrev_b32 v14, 5, v2
    v_lshlrev_b32 v14, 11, v14
    v_and_b32 v15, 31, v2
    v_lshlrev_b32 v15, 4, v15
    v_add_u32 v14, v14, v15
    s_lshl_b32 s16, s2, 14
    v_add_u32 v14, s16, v14
    v_add_u32 v15, 8192, v14
L_qpf_set:
    s_cmp_eq_u32 s14, 3
    s_cbranch_scc1 L_qpf_xa
    s_cmp_eq_u32 s14, 0
    s_cbranch_scc0 L_qpf_donea
    global_load_dword v16, v14, s[6:7]
    v_add_u32 v14, 1572864, v14
    s_branch L_qpf_donea
L_qpf_xa:
    global_load_dwordx4 v[16:19], v14, s[4:5]
    v_add_u32 v13, 4096, v14
    global_load_dwordx4 v[16:19], v15, s[4:5]
    global_load_dwordx4 v[16:19], v13, s[4:5]
    v_add_u32 v13, 4096, v15
    v_add_u32 v14, 512, v14
    global_load_dwordx4 v[16:19], v13, s[4:5]
    v_add_u32 v15, 512, v15
L_qpf_donea:
    s_cmp_eq_u32 s14, 0
    s_cbranch_scc0 L_nocas
    v_mov_b32 v243, 0
    s_cmp_eq_u32 s2, 0
    s_cbranch_scc0 L_nocas
    s_memrealtime s[16:17]
    s_waitcnt lgkmcnt(0)
    s_or_b32 s16, s16, 1
    v_mov_b32 v240, s16
    s_mov_b64 exec, 1
    global_store_dword v243, v240, s[44:45] sc1
    s_mov_b64 exec, -1
L_nocas:
    s_lshl_b32 s16, s2, 13
    s_lshl_b32 s17, s14, 11
    s_add_u32 s16, s16, s17
    v_add_u32 v4, s16, v3
    global_load_dwordx4 v[16:19], v4, s[40:41]
    global_load_dwordx4 v[16:19], v4, s[40:41] offset:1024
    s_getpc_b64 s[16:17]
L_pc:
    s_sub_u32 s16, s16, L_pc-standalone__softmax_full_mha__prompt_kernel
    s_subb_u32 s17, s17, 0
    v_lshlrev_b32 v4, 7, v2
    s_lshl_b32 s18, s14, 13
    v_add_u32 v4, s18, v4
    v_cmp_gt_u32 vcc, L_end-standalone__softmax_full_mha__prompt_kernel, v4
    s_and_saveexec_b64 s[18:19], vcc
    s_cbranch_execz L_nocode
    global_load_dword v16, v4, s[16:17]
L_nocode:
    s_mov_b64 exec, s[18:19]
    s_lshr_b32 s15, s14, 1
    s_and_b32 s16, s14, 1
    v_and_b32 v4, 31, v2
    s_lshl_b32 s17, s15, 6
    v_add_u32 v4, s17, v4
    v_lshlrev_b32 v4, 7, v4
    v_lshrrev_b32 v5, 1, v2
    v_and_b32 v5, 7, v5
    v_lshrrev_b32 v6, 5, v2
    v_xor_b32 v5, v5, v6
    v_xor_b32 v7, 0, v5
    v_lshlrev_b32 v7, 4, v7
    v_add_u32 v104, v4, v7
    v_xor_b32 v7, 2, v5
    v_lshlrev_b32 v7, 4, v7
    v_add_u32 v105, v4, v7
    v_xor_b32 v7, 4, v5
    v_lshlrev_b32 v7, 4, v7
    v_add_u32 v106, v4, v7
    v_xor_b32 v7, 6, v5
    v_lshlrev_b32 v7, 4, v7
    v_add_u32 v107, v4, v7
    v_and_b32 v7, 15, v2
    v_lshrrev_b32 v7, 2, v7
    v_lshlrev_b32 v8, 3, v6
    v_add_u32 v8, v8, v7
    v_lshlrev_b32 v8, 7, v8
    v_lshrrev_b32 v9, 4, v2
    v_and_b32 v9, 1, v9
    v_lshlrev_b32 v9, 1, v9
    v_and_b32 v10, 3, v2
    v_lshrrev_b32 v11, 1, v10
    v_add_u32 v9, v9, v11
    s_lshl_b32 s17, s16, 2
    v_add_u32 v9, s17, v9
    v_lshrrev_b32 v11, 1, v7
    v_lshlrev_b32 v11, 2, v11
    v_xor_b32 v9, v9, v11
    v_lshlrev_b32 v9, 4, v9
    v_add_u32 v8, v8, v9
    v_and_b32 v10, 1, v10
    v_lshlrev_b32 v10, 3, v10
    v_add_u32 v8, v8, v10
    v_add_u32 v108, 16384, v8
    v_mov_b32 v128, 0
    v_mov_b32 v129, 0
    v_mov_b32 v130, 0
    v_mov_b32 v131, 0
    v_mov_b32 v132, 0
    v_mov_b32 v133, 0
    v_mov_b32 v134, 0
    v_mov_b32 v135, 0
    v_mov_b32 v136, 0
    v_mov_b32 v137, 0
    v_mov_b32 v138, 0
    v_mov_b32 v139, 0
    v_mov_b32 v140, 0
    v_mov_b32 v141, 0
    v_mov_b32 v142, 0
    v_mov_b32 v143, 0
    v_mov_b32 v144, 0
    v_mov_b32 v145, 0
    v_mov_b32 v146, 0
    v_mov_b32 v147, 0
    v_mov_b32 v148, 0
    v_mov_b32 v149, 0
    v_mov_b32 v150, 0
    v_mov_b32 v151, 0
    v_mov_b32 v152, 0
    v_mov_b32 v153, 0
    v_mov_b32 v154, 0
    v_mov_b32 v155, 0
    v_mov_b32 v156, 0
    v_mov_b32 v157, 0
    v_mov_b32 v158, 0
    v_mov_b32 v159, 0
    v_mov_b32 v160, 0
    v_mov_b32 v161, 0
    v_mov_b32 v162, 0
    v_mov_b32 v163, 0
    v_mov_b32 v164, 0
    v_mov_b32 v165, 0
    v_mov_b32 v166, 0
    v_mov_b32 v167, 0
    v_mov_b32 v168, 0
    v_mov_b32 v169, 0
    v_mov_b32 v170, 0
    v_mov_b32 v171, 0
    v_mov_b32 v172, 0
    v_mov_b32 v173, 0
    v_mov_b32 v174, 0
    v_mov_b32 v175, 0
    v_mov_b32 v176, 0
    v_mov_b32 v177, 0
    v_mov_b32 v178, 0
    v_mov_b32 v179, 0
    v_mov_b32 v180, 0
    v_mov_b32 v181, 0
    v_mov_b32 v182, 0
    v_mov_b32 v183, 0
    v_mov_b32 v184, 0
    v_mov_b32 v185, 0
    v_mov_b32 v186, 0
    v_mov_b32 v187, 0
    v_mov_b32 v188, 0
    v_mov_b32 v189, 0
    v_mov_b32 v190, 0
    v_mov_b32 v191, 0
    v_mov_b32 v192, 0
    v_mov_b32 v193, 0
    v_mov_b32 v194, 0
    v_mov_b32 v195, 0
    v_mov_b32 v196, 0
    v_mov_b32 v197, 0
    v_mov_b32 v198, 0
    v_mov_b32 v199, 0
    v_mov_b32 v200, 0
    v_mov_b32 v201, 0
    v_mov_b32 v202, 0
    v_mov_b32 v203, 0
    v_mov_b32 v204, 0
    v_mov_b32 v205, 0
    v_mov_b32 v206, 0
    v_mov_b32 v207, 0
    v_mov_b32 v208, 0
    v_mov_b32 v209, 0
    v_mov_b32 v210, 0
    v_mov_b32 v211, 0
    v_mov_b32 v212, 0
    v_mov_b32 v213, 0
    v_mov_b32 v214, 0
    v_mov_b32 v215, 0
    v_mov_b32 v216, 0
    v_mov_b32 v217, 0
    v_mov_b32 v218, 0
    v_mov_b32 v219, 0
    v_mov_b32 v220, 0
    v_mov_b32 v221, 0
    v_mov_b32 v222, 0
    v_mov_b32 v223, 0
    s_lshr_b32 s50, s14, 2
    s_and_b32 s51, s14, 3
    s_lshl_b32 s52, s50, 12
    v_add_u32 v229, s52, v3
    v_add_u32 v230, 65536, v229
    v_and_b32 v4, 6, v2
    v_mov_b32 v5, 0x3f803f80
    v_cmp_eq_u32 vcc, 0, v4
    s_lshl_b32 s52, s51, 12
    v_mov_b32 v231, 1
    v_cndmask_b32 v224, 0, v5, vcc
    v_cndmask_b32 v225, 0, v5, vcc
    v_cmp_eq_u32 vcc, 4, v4
    v_add_u32 v235, s52, v3
    v_add_u32 v236, s52, v3
    v_cndmask_b32 v226, 0, v5, vcc
    v_cndmask_b32 v227, 0, v5, vcc
    v_and_b32 v4, 1, v2
    v_mov_b32 v5, 0x44444444
    v_mov_b32 v7, 0xeeeeeeee
    v_cmp_eq_u32 vcc, 0, v4
    v_add_u32 v237, s52, v3
    v_add_u32 v238, s52, v3
    v_cndmask_b32 v228, v7, v5, vcc
    s_lshl_b32 s52, s50, 2
    s_add_u32 s52, s52, 147520
    v_mov_b32 v233, s52
    s_lshl_b32 s52, s14, 8
    s_add_u32 s52, s52, 148480
    v_lshlrev_b32 v4, 2, v2
    v_add_u32 v232, s52, v4
    v_cmp_eq_u32 vcc, 0, v2
    s_lshl_b32 s52, s10, 13
    s_add_u32 s52, s52, 12582912
    v_cndmask_b32 v232, v232, v233, vcc
    v_lshlrev_b32 v239, 7, v2
    v_add_u32 v239, s52, v239
    s_lshl_b32 s17, s10, 1
    s_add_u32 s17, s17, s16
    s_lshl_b32 s19, s11, 2
    s_lshl_b32 s20, s15, 1
    s_add_u32 s19, s19, s20
    s_lshl_b32 s20, s17, 6
    s_add_u32 s20, s20, s19
    s_lshl_b32 s48, s20, 12
    s_lshl_b32 s20, s15, 14
    s_lshl_b32 s21, s16, 12
    s_add_u32 s20, s20, s21
    v_add_u32 v57, s20, v3
    s_lshl_b32 s20, s16, 2
    s_lshl_b32 s21, s15, 1
    s_add_u32 s20, s20, s21
    s_lshl_b32 s20, s20, 11
    s_add_u32 s20, s20, 131072
    v_add_u32 v58, s20, v3
    s_mov_b32 s23, 1048744942
    s_mov_b32 s18, 0
    s_mov_b32 s21, 4294844416
    s_mov_b32 s22, 40960
    s_barrier
    v_mov_b32 v243, 0
    global_load_dword v242, v243, s[44:45] sc1
    s_cmp_eq_u32 s14, 3
    s_cbranch_scc1 L_qpf_xb
    s_cmp_eq_u32 s14, 0
    s_cbranch_scc0 L_qpf_doneb
    global_load_dword v16, v14, s[6:7]
    v_add_u32 v14, 1572864, v14
    s_branch L_qpf_doneb
L_qpf_xb:
    global_load_dwordx4 v[16:19], v14, s[4:5]
    v_add_u32 v13, 4096, v14
    global_load_dwordx4 v[16:19], v15, s[4:5]
    global_load_dwordx4 v[16:19], v13, s[4:5]
    v_add_u32 v13, 4096, v15
    v_add_u32 v14, 512, v14
    global_load_dwordx4 v[16:19], v13, s[4:5]
    v_add_u32 v15, 512, v15
L_qpf_doneb:
    ds_read_b128 v[64:67], v104
    ds_read_b64_tr_b16 v[76:77], v108 offset:8192
    ds_read_b64_tr_b16 v[78:79], v108 offset:8704
    ds_read_b64_tr_b16 v[80:81], v108 offset:16384
    ds_read_b64_tr_b16 v[82:83], v108 offset:16896
    ds_read_b128 v[68:71], v104 offset:4096
    ds_read_b64_tr_b16 v[72:73], v108 offset:0
    ds_read_b64_tr_b16 v[74:75], v108 offset:512
.p2align 6
L_g1_loop:
    s_waitcnt lgkmcnt(5)
    v_mfma_f32_32x32x16_bf16 v[144:159], v[76:79], v[64:67], v[144:159]
    ds_read_b128 v[84:87], v105
    ds_read_b64_tr_b16 v[96:97], v108 offset:10240
    s_waitcnt lgkmcnt(5)
    v_mfma_f32_32x32x16_bf16 v[160:175], v[64:67], v[80:83], v[160:175]
    ds_read_b64_tr_b16 v[98:99], v108 offset:10752
    ds_read_b64_tr_b16 v[100:101], v108 offset:18432
    s_waitcnt lgkmcnt(6)
    v_mfma_f32_32x32x16_bf16 v[192:207], v[76:79], v[68:71], v[192:207]
    ds_read_b64_tr_b16 v[102:103], v108 offset:18944
    ds_read_b128 v[88:91], v105 offset:4096
    v_mfma_f32_32x32x16_bf16 v[208:223], v[68:71], v[80:83], v[208:223]
    ds_read_b64_tr_b16 v[92:93], v108 offset:2048
    ds_read_b64_tr_b16 v[94:95], v108 offset:2560
    s_waitcnt lgkmcnt(8)
    v_mfma_f32_32x32x16_bf16 v[128:143], v[72:75], v[64:67], v[128:143]
    v_mfma_f32_32x32x16_bf16 v[176:191], v[72:75], v[68:71], v[176:191]
    s_waitcnt lgkmcnt(5)
    v_mfma_f32_32x32x16_bf16 v[144:159], v[96:99], v[84:87], v[144:159]
    ds_read_b128 v[64:67], v106
    ds_read_b64_tr_b16 v[76:77], v108 offset:12288
    s_waitcnt lgkmcnt(5)
    v_mfma_f32_32x32x16_bf16 v[160:175], v[84:87], v[100:103], v[160:175]
    ds_read_b64_tr_b16 v[78:79], v108 offset:12800
    ds_read_b64_tr_b16 v[80:81], v108 offset:20480
    s_waitcnt lgkmcnt(6)
    v_mfma_f32_32x32x16_bf16 v[192:207], v[96:99], v[88:91], v[192:207]
    ds_read_b64_tr_b16 v[82:83], v108 offset:20992
    ds_read_b128 v[68:71], v106 offset:4096
    v_mfma_f32_32x32x16_bf16 v[208:223], v[88:91], v[100:103], v[208:223]
    ds_read_b64_tr_b16 v[72:73], v108 offset:4096
    ds_read_b64_tr_b16 v[74:75], v108 offset:4608
    s_waitcnt lgkmcnt(8)
    v_mfma_f32_32x32x16_bf16 v[128:143], v[92:95], v[84:87], v[128:143]
    v_mfma_f32_32x32x16_bf16 v[176:191], v[92:95], v[88:91], v[176:191]
    s_waitcnt lgkmcnt(5)
    v_mfma_f32_32x32x16_bf16 v[144:159], v[76:79], v[64:67], v[144:159]
    ds_read_b128 v[84:87], v107
    ds_read_b64_tr_b16 v[96:97], v108 offset:14336
    s_waitcnt lgkmcnt(5)
    v_mfma_f32_32x32x16_bf16 v[160:175], v[64:67], v[80:83], v[160:175]
    ds_read_b64_tr_b16 v[98:99], v108 offset:14848
    ds_read_b64_tr_b16 v[100:101], v108 offset:22528
    s_waitcnt lgkmcnt(6)
    v_mfma_f32_32x32x16_bf16 v[192:207], v[76:79], v[68:71], v[192:207]
    ds_read_b64_tr_b16 v[102:103], v108 offset:23040
    ds_read_b128 v[88:91], v107 offset:4096
    v_mfma_f32_32x32x16_bf16 v[208:223], v[68:71], v[80:83], v[208:223]
    ds_read_b64_tr_b16 v[92:93], v108 offset:6144
    ds_read_b64_tr_b16 v[94:95], v108 offset:6656
    s_waitcnt lgkmcnt(8)
    v_mfma_f32_32x32x16_bf16 v[128:143], v[72:75], v[64:67], v[128:143]
    v_mfma_f32_32x32x16_bf16 v[176:191], v[72:75], v[68:71], v[176:191]
    s_waitcnt lgkmcnt(0)
    s_add_u32 s18, s18, 1
    s_and_b32 s19, s18, 11
    s_cmp_eq_u32 s19, 2
    s_cbranch_scc1 L_qpf_out
L_qpf_back:
    s_and_b32 s19, s18, 3
    s_cmp_eq_u32 s19, 0
    s_cselect_b32 s20, s21, s22
    v_add_u32 v104, s20, v104
    v_add_u32 v105, s20, v105
    v_add_u32 v106, s20, v106
    v_add_u32 v107, s20, v107
    v_add_u32 v108, s20, v108
    s_barrier
    v_mfma_f32_32x32x16_bf16 v[144:159], v[96:99], v[84:87], v[144:159]
    ds_read_b128 v[64:67], v104
    ds_read_b64_tr_b16 v[76:77], v108 offset:8192
    v_mfma_f32_32x32x16_bf16 v[160:175], v[84:87], v[100:103], v[160:175]
    ds_read_b64_tr_b16 v[78:79], v108 offset:8704
    ds_read_b64_tr_b16 v[80:81], v108 offset:16384
    v_mfma_f32_32x32x16_bf16 v[192:207], v[96:99], v[88:91], v[192:207]
    ds_read_b64_tr_b16 v[82:83], v108 offset:16896
    ds_read_b128 v[68:71], v104 offset:4096
    v_mfma_f32_32x32x16_bf16 v[208:223], v[88:91], v[100:103], v[208:223]
    ds_read_b64_tr_b16 v[72:73], v108 offset:0
    ds_read_b64_tr_b16 v[74:75], v108 offset:512
    v_mfma_f32_32x32x16_bf16 v[128:143], v[92:95], v[84:87], v[128:143]
    v_mfma_f32_32x32x16_bf16 v[176:191], v[92:95], v[88:91], v[176:191]
    s_cmp_lt_u32 s18, 16
    s_cbranch_scc1 L_g1_loop
    s_waitcnt lgkmcnt(0) vmcnt(0)
    s_nop 11
    v_cvt_pk_bf16_f32 v64, v144, v145
    v_cvt_pk_bf16_f32 v65, v146, v147
    v_cvt_pk_bf16_f32 v66, v148, v149
    v_cvt_pk_bf16_f32 v67, v150, v151
    v_cvt_pk_bf16_f32 v68, v152, v153
    v_cvt_pk_bf16_f32 v69, v154, v155
    v_cvt_pk_bf16_f32 v70, v156, v157
    v_cvt_pk_bf16_f32 v71, v158, v159
    s_add_u32 s28, s48, 0
    buffer_store_dwordx4 v[64:67], v3, s[24:27], s28 offen sc1
    buffer_store_dwordx4 v[68:71], v3, s[24:27], s28 offen offset:1024 sc1
    ds_write_b128 v57, v[64:67] offset:0
    ds_write_b128 v57, v[68:71] offset:1024
    v_cvt_pk_bf16_f32 v72, v160, v161
    v_cvt_pk_bf16_f32 v73, v162, v163
    v_cvt_pk_bf16_f32 v74, v164, v165
    v_cvt_pk_bf16_f32 v75, v166, v167
    v_cvt_pk_bf16_f32 v76, v168, v169
    v_cvt_pk_bf16_f32 v77, v170, v171
    v_cvt_pk_bf16_f32 v78, v172, v173
    v_cvt_pk_bf16_f32 v79, v174, v175
    s_add_u32 s28, s48, 2048
    buffer_store_dwordx4 v[72:75], v3, s[24:27], s28 offen sc1
    buffer_store_dwordx4 v[76:79], v3, s[24:27], s28 offen offset:1024 sc1
    ds_write_b128 v57, v[72:75] offset:2048
    ds_write_b128 v57, v[76:79] offset:3072
    v_cvt_pk_bf16_f32 v80, v192, v193
    v_cvt_pk_bf16_f32 v81, v194, v195
    v_cvt_pk_bf16_f32 v82, v196, v197
    v_cvt_pk_bf16_f32 v83, v198, v199
    v_cvt_pk_bf16_f32 v84, v200, v201
    v_cvt_pk_bf16_f32 v85, v202, v203
    v_cvt_pk_bf16_f32 v86, v204, v205
    v_cvt_pk_bf16_f32 v87, v206, v207
    s_add_u32 s28, s48, 4096
    buffer_store_dwordx4 v[80:83], v3, s[24:27], s28 offen sc1
    buffer_store_dwordx4 v[84:87], v3, s[24:27], s28 offen offset:1024 sc1
    ds_write_b128 v57, v[80:83] offset:8192
    ds_write_b128 v57, v[84:87] offset:9216
    v_cvt_pk_bf16_f32 v88, v208, v209
    v_cvt_pk_bf16_f32 v89, v210, v211
    v_cvt_pk_bf16_f32 v90, v212, v213
    v_cvt_pk_bf16_f32 v91, v214, v215
    v_cvt_pk_bf16_f32 v92, v216, v217
    v_cvt_pk_bf16_f32 v93, v218, v219
    v_cvt_pk_bf16_f32 v94, v220, v221
    v_cvt_pk_bf16_f32 v95, v222, v223
    s_add_u32 s28, s48, 6144
    buffer_store_dwordx4 v[88:91], v3, s[24:27], s28 offen sc1
    buffer_store_dwordx4 v[92:95], v3, s[24:27], s28 offen offset:1024 sc1
    ds_write_b128 v57, v[88:91] offset:10240
    ds_write_b128 v57, v[92:95] offset:11264
    v_mul_f32 v128, s23, v128
    v_mul_f32 v129, s23, v129
    v_mul_f32 v130, s23, v130
    v_mul_f32 v131, s23, v131
    v_mul_f32 v132, s23, v132
    v_mul_f32 v133, s23, v133
    v_mul_f32 v134, s23, v134
    v_mul_f32 v135, s23, v135
    v_mul_f32 v136, s23, v136
    v_mul_f32 v137, s23, v137
    v_mul_f32 v138, s23, v138
    v_mul_f32 v139, s23, v139
    v_mul_f32 v140, s23, v140
    v_mul_f32 v141, s23, v141
    v_mul_f32 v142, s23, v142
    v_mul_f32 v143, s23, v143
    v_cvt_pk_bf16_f32 v96, v128, v129
    v_cvt_pk_bf16_f32 v97, v130, v131
    v_cvt_pk_bf16_f32 v98, v132, v133
    v_cvt_pk_bf16_f32 v99, v134, v135
    v_cvt_pk_bf16_f32 v100, v136, v137
    v_cvt_pk_bf16_f32 v101, v138, v139
    v_cvt_pk_bf16_f32 v102, v140, v141
    v_cvt_pk_bf16_f32 v103, v142, v143
    ds_write_b128 v58, v[96:99] offset:0
    ds_write_b128 v58, v[100:103] offset:1024
    v_mul_f32 v176, s23, v176
    v_mul_f32 v177, s23, v177
    v_mul_f32 v178, s23, v178
    v_mul_f32 v179, s23, v179
    v_mul_f32 v180, s23, v180
    v_mul_f32 v181, s23, v181
    v_mul_f32 v182, s23, v182
    v_mul_f32 v183, s23, v183
    v_mul_f32 v184, s23, v184
    v_mul_f32 v185, s23, v185
    v_mul_f32 v186, s23, v186
    v_mul_f32 v187, s23, v187
    v_mul_f32 v188, s23, v188
    v_mul_f32 v189, s23, v189
    v_mul_f32 v190, s23, v190
    v_mul_f32 v191, s23, v191
    v_cvt_pk_bf16_f32 v104, v176, v177
    v_cvt_pk_bf16_f32 v105, v178, v179
    v_cvt_pk_bf16_f32 v106, v180, v181
    v_cvt_pk_bf16_f32 v107, v182, v183
    v_cvt_pk_bf16_f32 v108, v184, v185
    v_cvt_pk_bf16_f32 v109, v186, v187
    v_cvt_pk_bf16_f32 v110, v188, v189
    v_cvt_pk_bf16_f32 v111, v190, v191
    ds_write_b128 v58, v[104:107] offset:2048
    ds_write_b128 v58, v[108:111] offset:3072
    s_cmp_eq_u32 s14, 0
    s_cbranch_scc0 L_noep
    s_mov_b32 s19, 0
L_tag_spin:
    v_readfirstlane_b32 s20, v242
    s_add_u32 s19, s19, 1
    s_cmp_lg_u32 s20, 0
    s_cbranch_scc1 L_tag_ok
    s_cmp_ge_u32 s19, 40000
    s_cbranch_scc1 L_tag_ok
    s_sleep 1
    global_load_dword v242, v243, s[44:45] sc1
    s_waitcnt vmcnt(0)
    s_branch L_tag_spin
L_tag_ok:
    v_mov_b32 v6, 147456
    s_mov_b64 exec, 1
    ds_write_b32 v6, v242
    v_mov_b32 v7, 0
    ds_write_b32 v6, v7 offset:64
    ds_write_b32 v6, v7 offset:68
    s_mov_b64 exec, -1
L_noep:
    s_waitcnt lgkmcnt(0)
L_g1_done:
    s_barrier
    s_lshr_b32 s15, s14, 2
    s_and_b32 s16, s14, 3
    s_lshl_b32 s17, s10, 1
    s_add_u32 s17, s17, s15
    s_lshl_b32 s18, s11, 2
    s_add_u32 s18, s18, s16
    s_lshl_b32 s20, s14, 11
    s_add_u32 s20, s20, 131072
    v_add_u32 v4, s20, v3
    ds_read_b128 v[8:11], v4
    ds_read_b128 v[12:15], v4 offset:1024
    v_mov_b32 v6, 147456
    ds_read_b32 v6, v6
    ds_read_b128 v[16:19], v229
    ds_read_b128 v[20:23], v229 offset:1024
    v_mov_b32 v96, 0
    v_mov_b32 v97, 0
    v_mov_b32 v98, 0
    v_mov_b32 v99, 0
    s_lshl_b32 s20, s17, 18
    s_add_u32 s28, s8, s20
    s_addc_u32 s29, s9, 0
    s_mov_b32 s30, 262144
    s_mov_b32 s31, 0x20000
    s_lshl_b32 s21, s16, 13
    s_lshl_b32 s36, s15, 12
    s_add_u32 s21, s21, s36
    s_waitcnt lgkmcnt(0)
    v_readfirstlane_b32 s46, v6
    v_mfma_f32_32x32x16_bf16 v[32:47], v[16:19], v[8:11], 0
    v_mfma_f32_32x32x16_bf16 v[32:47], v[20:23], v[12:15], v[32:47]
    ds_read_b128 v[16:19], v229 offset:8192
    ds_read_b128 v[20:23], v229 offset:9216
    s_nop 7
    s_setprio 3
    s_waitcnt lgkmcnt(0)
    v_mfma_f32_32x32x16_bf16 v[48:63], v[16:19], v[8:11], 0
    v_exp_f32 v32, v32
    v_exp_f32 v33, v33
    v_exp_f32 v34, v34
    v_exp_f32 v35, v35
    v_mfma_f32_32x32x16_bf16 v[48:63], v[20:23], v[12:15], v[48:63]
    ds_read_b128 v[16:19], v229 offset:16384
    ds_read_b128 v[20:23], v229 offset:17408
    v_exp_f32 v36, v36
    v_exp_f32 v37, v37
    v_exp_f32 v38, v38
    v_exp_f32 v39, v39
    v_exp_f32 v40, v40
    v_exp_f32 v41, v41
    v_exp_f32 v42, v42
    v_exp_f32 v43, v43
    v_exp_f32 v44, v44
    v_exp_f32 v45, v45
    v_exp_f32 v46, v46
    v_exp_f32 v47, v47
    ds_read_b128 v[24:27], v229 offset:2048
    ds_read_b128 v[28:31], v229 offset:3072
    s_nop 0
    v_cvt_pk_bf16_f32 v64, v32, v33
    v_cvt_pk_bf16_f32 v65, v34, v35
    v_cvt_pk_bf16_f32 v66, v36, v37
    v_cvt_pk_bf16_f32 v67, v38, v39
    v_cvt_pk_bf16_f32 v68, v40, v41
    v_cvt_pk_bf16_f32 v69, v42, v43
    v_cvt_pk_bf16_f32 v70, v44, v45
    v_cvt_pk_bf16_f32 v71, v46, v47
    s_setprio 2
    s_waitcnt lgkmcnt(2)
    v_mfma_f32_32x32x16_bf16 v[32:47], v[16:19], v[8:11], 0
    v_exp_f32 v48, v48
    v_exp_f32 v49, v49
    v_exp_f32 v50, v50
    v_exp_f32 v51, v51
    v_mfma_f32_32x32x16_bf16 v[32:47], v[20:23], v[12:15], v[32:47]
    ds_read_b128 v[16:19], v229 offset:24576
    ds_read_b128 v[20:23], v229 offset:25600
    v_exp_f32 v52, v52
    v_exp_f32 v53, v53
    v_exp_f32 v54, v54
    v_exp_f32 v55, v55
    s_waitcnt lgkmcnt(2)
    v_mfma_f32_32x32x16_bf16 v[80:95], v[24:27], v[64:67], 0
    v_exp_f32 v56, v56
    v_exp_f32 v57, v57
    v_exp_f32 v58, v58
    v_exp_f32 v59, v59
    v_mfma_f32_32x32x16_bf16 v[80:95], v[28:31], v[68:71], v[80:95]
    v_exp_f32 v60, v60
    v_exp_f32 v61, v61
    v_exp_f32 v62, v62
    v_exp_f32 v63, v63
    v_smfmac_f32_16x16x64_bf16 v[96:99], v[224:227], v[64:71], v228
    ds_read_b128 v[24:27], v229 offset:10240
    ds_read_b128 v[28:31], v229 offset:11264
    v_cvt_pk_bf16_f32 v72, v48, v49
    v_cvt_pk_bf16_f32 v73, v50, v51
    v_cvt_pk_bf16_f32 v74, v52, v53
    v_cvt_pk_bf16_f32 v75, v54, v55
    v_cvt_pk_bf16_f32 v76, v56, v57
    v_cvt_pk_bf16_f32 v77, v58, v59
    v_cvt_pk_bf16_f32 v78, v60, v61
    v_cvt_pk_bf16_f32 v79, v62, v63
    s_setprio 1
    s_cmp_lt_u32 s14, 4
    s_cbranch_scc1 L_flag_out
L_flag_back:
    s_waitcnt lgkmcnt(2)
    v_mfma_f32_32x32x16_bf16 v[48:63], v[16:19], v[8:11], 0
    v_exp_f32 v32, v32
    v_exp_f32 v33, v33
    v_exp_f32 v34, v34
    v_exp_f32 v35, v35
    v_mfma_f32_32x32x16_bf16 v[48:63], v[20:23], v[12:15], v[48:63]
    v_exp_f32 v36, v36
    v_exp_f32 v37, v37
    v_exp_f32 v38, v38
    v_exp_f32 v39, v39
    s_waitcnt lgkmcnt(0)
    v_mfma_f32_32x32x16_bf16 v[80:95], v[24:27], v[72:75], v[80:95]
    v_exp_f32 v40, v40
    v_exp_f32 v41, v41
    v_exp_f32 v42, v42
    v_exp_f32 v43, v43
    v_mfma_f32_32x32x16_bf16 v[80:95], v[28:31], v[76:79], v[80:95]
    v_exp_f32 v44, v44
    v_exp_f32 v45, v45
    v_exp_f32 v46, v46
    v_exp_f32 v47, v47
    v_smfmac_f32_16x16x64_bf16 v[96:99], v[224:227], v[72:79], v228
    ds_read_b128 v[24:27], v229 offset:18432
    ds_read_b128 v[28:31], v229 offset:19456
    v_cvt_pk_bf16_f32 v64, v32, v33
    v_cvt_pk_bf16_f32 v65, v34, v35
    v_cvt_pk_bf16_f32 v66, v36, v37
    v_cvt_pk_bf16_f32 v67, v38, v39
    v_cvt_pk_bf16_f32 v68, v40, v41
    v_cvt_pk_bf16_f32 v69, v42, v43
    v_cvt_pk_bf16_f32 v70, v44, v45
    v_cvt_pk_bf16_f32 v71, v46, v47
    s_setprio 0
    v_exp_f32 v48, v48
    v_exp_f32 v49, v49
    v_exp_f32 v50, v50
    v_exp_f32 v51, v51
    v_exp_f32 v52, v52
    v_exp_f32 v53, v53
    v_exp_f32 v54, v54
    v_exp_f32 v55, v55
    s_waitcnt lgkmcnt(0)
    v_mfma_f32_32x32x16_bf16 v[80:95], v[24:27], v[64:67], v[80:95]
    v_exp_f32 v56, v56
    v_exp_f32 v57, v57
    v_exp_f32 v58, v58
    v_exp_f32 v59, v59
    v_mfma_f32_32x32x16_bf16 v[80:95], v[28:31], v[68:71], v[80:95]
    v_exp_f32 v60, v60
    v_exp_f32 v61, v61
    v_exp_f32 v62, v62
    v_exp_f32 v63, v63
    v_smfmac_f32_16x16x64_bf16 v[96:99], v[224:227], v[64:71], v228
    ds_read_b128 v[24:27], v229 offset:26624
    ds_read_b128 v[28:31], v229 offset:27648
    v_cvt_pk_bf16_f32 v72, v48, v49
    v_cvt_pk_bf16_f32 v73, v50, v51
    v_cvt_pk_bf16_f32 v74, v52, v53
    v_cvt_pk_bf16_f32 v75, v54, v55
    v_cvt_pk_bf16_f32 v76, v56, v57
    v_cvt_pk_bf16_f32 v77, v58, v59
    v_cvt_pk_bf16_f32 v78, v60, v61
    v_cvt_pk_bf16_f32 v79, v62, v63
    s_cmp_eq_u32 s14, 7
    s_cbranch_scc0 L_at_nopoll
    s_cmp_lt_u32 s11, 3
    s_cselect_b32 s48, 16, 12
    s_bfm_b32 s48, s48, 0
    s_mov_b32 s49, 0
    s_mov_b32 s47, 0
L_poll_f:
    buffer_load_dword v5, v239, s[24:27], 0 offen sc1
    s_waitcnt vmcnt(0)
    v_cmp_ne_u32 vcc, s46, v5
    s_add_u32 s47, s47, 1
    s_and_b64 vcc, vcc, s[48:49]
    s_cmp_eq_u64 vcc, 0
    s_cbranch_scc1 L_poll_f_done
    s_cmp_ge_u32 s47, 40000
    s_cbranch_scc1 L_poll_f_done
    s_sleep 1
    s_branch L_poll_f
L_poll_f_done:
    s_branch L_at_nopoll
    s_add_u32 s36, s11, 1
    s_lshl_b32 s36, s36, 2
    s_and_b32 s36, s36, 63
    s_sub_u32 s37, 64, s36
    s_mov_b64 s[58:59], 0xfff
    s_lshl_b64 s[48:49], s[58:59], s36
    s_lshr_b64 s[58:59], s[58:59], s37
    s_cmp_eq_u32 s36, 0
    s_cselect_b64 s[58:59], 0, s[58:59]
    s_or_b64 s[48:49], s[48:49], s[58:59]
L_at_nopoll:
    s_barrier
    s_cmp_le_u32 s11, 0
    s_cselect_b32 s36, 1, 0
    s_add_u32 m0, s21, 32768
    s_lshl_b32 s36, s36, 14
    buffer_load_dwordx4 v235, s[28:31], s36 offen offset:0 sc1 lds
    buffer_load_dwordx4 v236, s[28:31], s36 offen offset:1024 sc1 lds
    buffer_load_dwordx4 v237, s[28:31], s36 offen offset:2048 sc1 lds
    buffer_load_dwordx4 v238, s[28:31], s36 offen offset:3072 sc1 lds
    s_cmp_le_u32 s11, 1
    s_cselect_b32 s36, 2, 1
    s_add_u32 m0, s21, 65536
    s_lshl_b32 s36, s36, 14
    buffer_load_dwordx4 v235, s[28:31], s36 offen offset:0 sc1 lds
    buffer_load_dwordx4 v236, s[28:31], s36 offen offset:1024 sc1 lds
    buffer_load_dwordx4 v237, s[28:31], s36 offen offset:2048 sc1 lds
    buffer_load_dwordx4 v238, s[28:31], s36 offen offset:3072 sc1 lds
    s_cmp_le_u32 s11, 3
    s_cselect_b32 s55, 4, 3
    s_lshl_b32 s60, s11, 14
    s_lshl_b32 s55, s55, 14
    s_mov_b32 s56, 16384
    s_mov_b32 s57, 0x3c000
    s_mov_b32 s47, 4
    s_waitcnt vmcnt(4)
    s_barrier
    s_and_b32 s36, s14, 3
    s_cmp_eq_u32 s36, 3
    s_cbranch_scc0 L_at_nopoll2
    s_mov_b32 s47, 0
L_poll_f2:
    buffer_load_dword v5, v239, s[24:27], 0 offen sc1
    s_waitcnt vmcnt(0)
    v_cmp_ne_u32 vcc, s46, v5
    s_add_u32 s47, s47, 1
    s_cmp_eq_u64 vcc, 0
    s_cbranch_scc1 L_poll_f2_done
    s_cmp_ge_u32 s47, 40000
    s_cbranch_scc1 L_poll_f2_done
    s_sleep 1
    s_branch L_poll_f2
L_poll_f2_done:
    s_mov_b32 s47, 4
L_at_nopoll2:
    s_cmp_le_u32 s11, 2
    s_cselect_b32 s36, 3, 2
    s_add_u32 m0, s21, 98304
    s_lshl_b32 s36, s36, 14
    buffer_load_dwordx4 v235, s[28:31], s36 offen offset:0 sc1 lds
    buffer_load_dwordx4 v236, s[28:31], s36 offen offset:1024 sc1 lds
    buffer_load_dwordx4 v237, s[28:31], s36 offen offset:2048 sc1 lds
    buffer_load_dwordx4 v238, s[28:31], s36 offen offset:3072 sc1 lds
    ds_read_b128 v[16:19], v229 offset:32768
    ds_read_b128 v[20:23], v229 offset:33792
    s_waitcnt lgkmcnt(0)
    v_mfma_f32_32x32x16_bf16 v[32:47], v[16:19], v[8:11], 0
    v_mfma_f32_32x32x16_bf16 v[32:47], v[20:23], v[12:15], v[32:47]
    ds_read_b128 v[16:19], v229 offset:40960
    ds_read_b128 v[20:23], v229 offset:41984
    s_waitcnt lgkmcnt(0)
    s_nop 7
.p2align 6
L_at_loop:
    s_setprio 3
    s_waitcnt lgkmcnt(2)
    v_mfma_f32_32x32x16_bf16 v[48:63], v[16:19], v[8:11], 0
    v_exp_f32 v32, v32
    v_exp_f32 v33, v33
    v_exp_f32 v34, v34
    v_exp_f32 v35, v35
    v_mfma_f32_32x32x16_bf16 v[48:63], v[20:23], v[12:15], v[48:63]
    ds_read_b128 v[16:19], v229 offset:49152
    ds_read_b128 v[20:23], v229 offset:50176
    v_exp_f32 v36, v36
    v_exp_f32 v37, v37
    v_exp_f32 v38, v38
    v_exp_f32 v39, v39
    s_waitcnt lgkmcnt(2)
    s_waitcnt vmcnt(4)
    ds_add_u32 v232, v231
    v_mfma_f32_32x32x16_bf16 v[80:95], v[24:27], v[72:75], v[80:95]
    v_exp_f32 v40, v40
    v_exp_f32 v41, v41
    v_exp_f32 v42, v42
    v_exp_f32 v43, v43
    v_mfma_f32_32x32x16_bf16 v[80:95], v[28:31], v[76:79], v[80:95]
    v_exp_f32 v44, v44
    v_exp_f32 v45, v45
    v_exp_f32 v46, v46
    v_exp_f32 v47, v47
    v_smfmac_f32_16x16x64_bf16 v[96:99], v[224:227], v[72:79], v228
    ds_read_b128 v[24:27], v229 offset:34816
    ds_read_b128 v[28:31], v229 offset:35840
    v_cvt_pk_bf16_f32 v64, v32, v33
    v_cvt_pk_bf16_f32 v65, v34, v35
    v_cvt_pk_bf16_f32 v66, v36, v37
    v_cvt_pk_bf16_f32 v67, v38, v39
    v_cvt_pk_bf16_f32 v68, v40, v41
    v_cvt_pk_bf16_f32 v69, v42, v43
    v_cvt_pk_bf16_f32 v70, v44, v45
    v_cvt_pk_bf16_f32 v71, v46, v47
    s_setprio 2
    s_waitcnt lgkmcnt(3)
    v_mfma_f32_32x32x16_bf16 v[32:47], v[16:19], v[8:11], 0
    v_exp_f32 v48, v48
    v_exp_f32 v49, v49
    v_exp_f32 v50, v50
    v_exp_f32 v51, v51
    v_mfma_f32_32x32x16_bf16 v[32:47], v[20:23], v[12:15], v[32:47]
    ds_read_b128 v[16:19], v229 offset:57344
    ds_read_b128 v[20:23], v229 offset:58368
    v_exp_f32 v52, v52
    v_exp_f32 v53, v53
    v_exp_f32 v54, v54
    v_exp_f32 v55, v55
    s_waitcnt lgkmcnt(2)
    v_mfma_f32_32x32x16_bf16 v[80:95], v[24:27], v[64:67], v[80:95]
    v_exp_f32 v56, v56
    v_exp_f32 v57, v57
    v_exp_f32 v58, v58
    v_exp_f32 v59, v59
    v_mfma_f32_32x32x16_bf16 v[80:95], v[28:31], v[68:71], v[80:95]
    ds_read_b32 v234, v233
    v_exp_f32 v60, v60
    v_exp_f32 v61, v61
    v_exp_f32 v62, v62
    v_exp_f32 v63, v63
    v_smfmac_f32_16x16x64_bf16 v[96:99], v[224:227], v[64:71], v228
    ds_read_b128 v[24:27], v229 offset:43008
    ds_read_b128 v[28:31], v229 offset:44032
    v_cvt_pk_bf16_f32 v72, v48, v49
    v_cvt_pk_bf16_f32 v73, v50, v51
    v_cvt_pk_bf16_f32 v74, v52, v53
    v_cvt_pk_bf16_f32 v75, v54, v55
    v_cvt_pk_bf16_f32 v76, v56, v57
    v_cvt_pk_bf16_f32 v77, v58, v59
    v_cvt_pk_bf16_f32 v78, v60, v61
    v_cvt_pk_bf16_f32 v79, v62, v63
    s_setprio 1
    s_waitcnt lgkmcnt(3)
    v_mfma_f32_32x32x16_bf16 v[48:63], v[16:19], v[8:11], 0
    v_exp_f32 v32, v32
    v_exp_f32 v33, v33
    v_exp_f32 v34, v34
    v_exp_f32 v35, v35
    v_mfma_f32_32x32x16_bf16 v[48:63], v[20:23], v[12:15], v[48:63]
    s_waitcnt lgkmcnt(2)
    v_cmp_gt_u32 vcc, s47, v234
    v_exp_f32 v36, v36
    v_exp_f32 v37, v37
    s_cbranch_vccnz L_cnt_spin0
L_cnt_back0:
    ds_read_b128 v[16:19], v230 offset:0
    ds_read_b128 v[20:23], v230 offset:1024
    v_exp_f32 v38, v38
    v_exp_f32 v39, v39
    s_waitcnt lgkmcnt(2)
    v_mfma_f32_32x32x16_bf16 v[80:95], v[24:27], v[72:75], v[80:95]
    v_exp_f32 v40, v40
    s_add_u32 m0, s21, 0
    v_exp_f32 v41, v41
    buffer_load_dwordx4 v235, s[28:31], s55 offen offset:0 sc1 lds
    v_exp_f32 v42, v42
    v_exp_f32 v43, v43
    v_mfma_f32_32x32x16_bf16 v[80:95], v[28:31], v[76:79], v[80:95]
    buffer_load_dwordx4 v236, s[28:31], s55 offen offset:1024 sc1 lds
    v_exp_f32 v44, v44
    v_exp_f32 v45, v45
    v_exp_f32 v46, v46
    v_exp_f32 v47, v47
    v_smfmac_f32_16x16x64_bf16 v[96:99], v[224:227], v[72:79], v228
    ds_read_b128 v[24:27], v229 offset:51200
    ds_read_b128 v[28:31], v229 offset:52224
    v_cvt_pk_bf16_f32 v64, v32, v33
    v_cvt_pk_bf16_f32 v65, v34, v35
    v_cvt_pk_bf16_f32 v66, v36, v37
    v_cvt_pk_bf16_f32 v67, v38, v39
    v_cvt_pk_bf16_f32 v68, v40, v41
    v_cvt_pk_bf16_f32 v69, v42, v43
    v_cvt_pk_bf16_f32 v70, v44, v45
    v_cvt_pk_bf16_f32 v71, v46, v47
    s_setprio 0
    s_waitcnt lgkmcnt(2)
    v_mfma_f32_32x32x16_bf16 v[32:47], v[16:19], v[8:11], 0
    v_exp_f32 v48, v48
    v_exp_f32 v49, v49
    v_exp_f32 v50, v50
    v_exp_f32 v51, v51
    v_mfma_f32_32x32x16_bf16 v[32:47], v[20:23], v[12:15], v[32:47]
    ds_read_b128 v[16:19], v230 offset:8192
    ds_read_b128 v[20:23], v230 offset:9216
    v_exp_f32 v52, v52
    v_exp_f32 v53, v53
    v_exp_f32 v54, v54
    v_exp_f32 v55, v55
    s_waitcnt lgkmcnt(2)
    v_mfma_f32_32x32x16_bf16 v[80:95], v[24:27], v[64:67], v[80:95]
    v_exp_f32 v56, v56
    v_exp_f32 v57, v57
    buffer_load_dwordx4 v237, s[28:31], s55 offen offset:2048 sc1 lds
    v_exp_f32 v58, v58
    v_exp_f32 v59, v59
    v_mfma_f32_32x32x16_bf16 v[80:95], v[28:31], v[68:71], v[80:95]
    buffer_load_dwordx4 v238, s[28:31], s55 offen offset:3072 sc1 lds
    v_exp_f32 v60, v60
    v_exp_f32 v61, v61
    v_exp_f32 v62, v62
    v_exp_f32 v63, v63
    v_smfmac_f32_16x16x64_bf16 v[96:99], v[224:227], v[64:71], v228
    ds_read_b128 v[24:27], v229 offset:59392
    ds_read_b128 v[28:31], v229 offset:60416
    v_cvt_pk_bf16_f32 v72, v48, v49
    v_cvt_pk_bf16_f32 v73, v50, v51
    v_cvt_pk_bf16_f32 v74, v52, v53
    s_add_u32 s55, s55, s56
    v_cvt_pk_bf16_f32 v75, v54, v55
    v_cvt_pk_bf16_f32 v76, v56, v57
    s_and_b32 s55, s55, s57
    s_cmp_eq_u32 s55, s60
    s_cselect_b32 s36, 16384, 0
    v_cvt_pk_bf16_f32 v77, v58, v59
    v_cvt_pk_bf16_f32 v78, v60, v61
    s_add_u32 s47, s47, 4
    s_add_u32 s55, s55, s36
    v_cvt_pk_bf16_f32 v79, v62, v63
    s_setprio 3
    s_waitcnt lgkmcnt(2)
    v_mfma_f32_32x32x16_bf16 v[48:63], v[16:19], v[8:11], 0
    v_exp_f32 v32, v32
    v_exp_f32 v33, v33
    v_exp_f32 v34, v34
    v_exp_f32 v35, v35
    v_mfma_f32_32x32x16_bf16 v[48:63], v[20:23], v[12:15], v[48:63]
    ds_read_b128 v[16:19], v230 offset:16384
    ds_read_b128 v[20:23], v230 offset:17408
    v_exp_f32 v36, v36
    v_exp_f32 v37, v37
    v_exp_f32 v38, v38
    v_exp_f32 v39, v39
    s_waitcnt lgkmcnt(2)
    s_waitcnt vmcnt(4)
    ds_add_u32 v232, v231
    v_mfma_f32_32x32x16_bf16 v[80:95], v[24:27], v[72:75], v[80:95]
    v_exp_f32 v40, v40
    v_exp_f32 v41, v41
    v_exp_f32 v42, v42
    v_exp_f32 v43, v43
    v_mfma_f32_32x32x16_bf16 v[80:95], v[28:31], v[76:79], v[80:95]
    v_exp_f32 v44, v44
    v_exp_f32 v45, v45
    v_exp_f32 v46, v46
    v_exp_f32 v47, v47
    v_smfmac_f32_16x16x64_bf16 v[96:99], v[224:227], v[72:79], v228
    ds_read_b128 v[24:27], v230 offset:2048
    ds_read_b128 v[28:31], v230 offset:3072
    v_cvt_pk_bf16_f32 v64, v32, v33
    v_cvt_pk_bf16_f32 v65, v34, v35
    v_cvt_pk_bf16_f32 v66, v36, v37
    v_cvt_pk_bf16_f32 v67, v38, v39
    v_cvt_pk_bf16_f32 v68, v40, v41
    v_cvt_pk_bf16_f32 v69, v42, v43
    v_cvt_pk_bf16_f32 v70, v44, v45
    v_cvt_pk_bf16_f32 v71, v46, v47
    s_setprio 2
    s_waitcnt lgkmcnt(3)
    v_mfma_f32_32x32x16_bf16 v[32:47], v[16:19], v[8:11], 0
    v_exp_f32 v48, v48
    v_exp_f32 v49, v49
    v_exp_f32 v50, v50
    v_exp_f32 v51, v51
    v_mfma_f32_32x32x16_bf16 v[32:47], v[20:23], v[12:15], v[32:47]
    ds_read_b128 v[16:19], v230 offset:24576
    ds_read_b128 v[20:23], v230 offset:25600
    v_exp_f32 v52, v52
    v_exp_f32 v53, v53
    v_exp_f32 v54, v54
    v_exp_f32 v55, v55
    s_waitcnt lgkmcnt(2)
    v_mfma_f32_32x32x16_bf16 v[80:95], v[24:27], v[64:67], v[80:95]
    v_exp_f32 v56, v56
    v_exp_f32 v57, v57
    v_exp_f32 v58, v58
    v_exp_f32 v59, v59
    v_mfma_f32_32x32x16_bf16 v[80:95], v[28:31], v[68:71], v[80:95]
    ds_read_b32 v234, v233
    v_exp_f32 v60, v60
    v_exp_f32 v61, v61
    v_exp_f32 v62, v62
    v_exp_f32 v63, v63
    v_smfmac_f32_16x16x64_bf16 v[96:99], v[224:227], v[64:71], v228
    ds_read_b128 v[24:27], v230 offset:10240
    ds_read_b128 v[28:31], v230 offset:11264
    v_cvt_pk_bf16_f32 v72, v48, v49
    v_cvt_pk_bf16_f32 v73, v50, v51
    v_cvt_pk_bf16_f32 v74, v52, v53
    v_cvt_pk_bf16_f32 v75, v54, v55
    v_cvt_pk_bf16_f32 v76, v56, v57
    v_cvt_pk_bf16_f32 v77, v58, v59
    v_cvt_pk_bf16_f32 v78, v60, v61
    v_cvt_pk_bf16_f32 v79, v62, v63
    s_setprio 1
    s_waitcnt lgkmcnt(3)
    v_mfma_f32_32x32x16_bf16 v[48:63], v[16:19], v[8:11], 0
    v_exp_f32 v32, v32
    v_exp_f32 v33, v33
    v_exp_f32 v34, v34
    v_exp_f32 v35, v35
    v_mfma_f32_32x32x16_bf16 v[48:63], v[20:23], v[12:15], v[48:63]
    s_waitcnt lgkmcnt(2)
    v_cmp_gt_u32 vcc, s47, v234
    v_exp_f32 v36, v36
    v_exp_f32 v37, v37
    s_cbranch_vccnz L_cnt_spin1
L_cnt_back1:
    ds_read_b128 v[16:19], v230 offset:32768
    ds_read_b128 v[20:23], v230 offset:33792
    v_exp_f32 v38, v38
    v_exp_f32 v39, v39
    s_waitcnt lgkmcnt(2)
    v_mfma_f32_32x32x16_bf16 v[80:95], v[24:27], v[72:75], v[80:95]
    v_exp_f32 v40, v40
    s_add_u32 m0, s21, 32768
    v_exp_f32 v41, v41
    buffer_load_dwordx4 v235, s[28:31], s55 offen offset:0 sc1 lds
    v_exp_f32 v42, v42
    v_exp_f32 v43, v43
    v_mfma_f32_32x32x16_bf16 v[80:95], v[28:31], v[76:79], v[80:95]
    buffer_load_dwordx4 v236, s[28:31], s55 offen offset:1024 sc1 lds
    v_exp_f32 v44, v44
    v_exp_f32 v45, v45
    v_exp_f32 v46, v46
    v_exp_f32 v47, v47
    v_smfmac_f32_16x16x64_bf16 v[96:99], v[224:227], v[72:79], v228
    ds_read_b128 v[24:27], v230 offset:18432
    ds_read_b128 v[28:31], v230 offset:19456
    v_cvt_pk_bf16_f32 v64, v32, v33
    v_cvt_pk_bf16_f32 v65, v34, v35
    v_cvt_pk_bf16_f32 v66, v36, v37
    v_cvt_pk_bf16_f32 v67, v38, v39
    v_cvt_pk_bf16_f32 v68, v40, v41
    v_cvt_pk_bf16_f32 v69, v42, v43
    v_cvt_pk_bf16_f32 v70, v44, v45
    v_cvt_pk_bf16_f32 v71, v46, v47
    s_setprio 0
    s_waitcnt lgkmcnt(2)
    v_mfma_f32_32x32x16_bf16 v[32:47], v[16:19], v[8:11], 0
    v_exp_f32 v48, v48
    v_exp_f32 v49, v49
    v_exp_f32 v50, v50
    v_exp_f32 v51, v51
    v_mfma_f32_32x32x16_bf16 v[32:47], v[20:23], v[12:15], v[32:47]
    ds_read_b128 v[16:19], v230 offset:40960
    ds_read_b128 v[20:23], v230 offset:41984
    v_exp_f32 v52, v52
    v_exp_f32 v53, v53
    v_exp_f32 v54, v54
    v_exp_f32 v55, v55
    s_waitcnt lgkmcnt(2)
    v_mfma_f32_32x32x16_bf16 v[80:95], v[24:27], v[64:67], v[80:95]
    v_exp_f32 v56, v56
    v_exp_f32 v57, v57
    buffer_load_dwordx4 v237, s[28:31], s55 offen offset:2048 sc1 lds
    v_exp_f32 v58, v58
    v_exp_f32 v59, v59
    v_mfma_f32_32x32x16_bf16 v[80:95], v[28:31], v[68:71], v[80:95]
    buffer_load_dwordx4 v238, s[28:31], s55 offen offset:3072 sc1 lds
    v_exp_f32 v60, v60
    v_exp_f32 v61, v61
    v_exp_f32 v62, v62
    v_exp_f32 v63, v63
    v_smfmac_f32_16x16x64_bf16 v[96:99], v[224:227], v[64:71], v228
    ds_read_b128 v[24:27], v230 offset:26624
    ds_read_b128 v[28:31], v230 offset:27648
    v_cvt_pk_bf16_f32 v72, v48, v49
    v_cvt_pk_bf16_f32 v73, v50, v51
    v_cvt_pk_bf16_f32 v74, v52, v53
    s_add_u32 s55, s55, s56
    v_cvt_pk_bf16_f32 v75, v54, v55
    v_cvt_pk_bf16_f32 v76, v56, v57
    s_and_b32 s55, s55, s57
    s_cmp_eq_u32 s55, s60
    s_cselect_b32 s36, 16384, 0
    v_cvt_pk_bf16_f32 v77, v58, v59
    v_cvt_pk_bf16_f32 v78, v60, v61
    s_add_u32 s47, s47, 4
    s_add_u32 s55, s55, s36
    v_cvt_pk_bf16_f32 v79, v62, v63
    s_setprio 3
    s_waitcnt lgkmcnt(2)
    v_mfma_f32_32x32x16_bf16 v[48:63], v[16:19], v[8:11], 0
    v_exp_f32 v32, v32
    v_exp_f32 v33, v33
    v_exp_f32 v34, v34
    v_exp_f32 v35, v35
    v_mfma_f32_32x32x16_bf16 v[48:63], v[20:23], v[12:15], v[48:63]
    ds_read_b128 v[16:19], v230 offset:49152
    ds_read_b128 v[20:23], v230 offset:50176
    v_exp_f32 v36, v36
    v_exp_f32 v37, v37
    v_exp_f32 v38, v38
    v_exp_f32 v39, v39
    s_waitcnt lgkmcnt(2)
    s_waitcnt vmcnt(4)
    ds_add_u32 v232, v231
    v_mfma_f32_32x32x16_bf16 v[80:95], v[24:27], v[72:75], v[80:95]
    v_exp_f32 v40, v40
    v_exp_f32 v41, v41
    v_exp_f32 v42, v42
    v_exp_f32 v43, v43
    v_mfma_f32_32x32x16_bf16 v[80:95], v[28:31], v[76:79], v[80:95]
    v_exp_f32 v44, v44
    v_exp_f32 v45, v45
    v_exp_f32 v46, v46
    v_exp_f32 v47, v47
    v_smfmac_f32_16x16x64_bf16 v[96:99], v[224:227], v[72:79], v228
    ds_read_b128 v[24:27], v230 offset:34816
    ds_read_b128 v[28:31], v230 offset:35840
    v_cvt_pk_bf16_f32 v64, v32, v33
    v_cvt_pk_bf16_f32 v65, v34, v35
    v_cvt_pk_bf16_f32 v66, v36, v37
    v_cvt_pk_bf16_f32 v67, v38, v39
    v_cvt_pk_bf16_f32 v68, v40, v41
    v_cvt_pk_bf16_f32 v69, v42, v43
    v_cvt_pk_bf16_f32 v70, v44, v45
    v_cvt_pk_bf16_f32 v71, v46, v47
    s_setprio 2
    s_waitcnt lgkmcnt(3)
    v_mfma_f32_32x32x16_bf16 v[32:47], v[16:19], v[8:11], 0
    v_exp_f32 v48, v48
    v_exp_f32 v49, v49
    v_exp_f32 v50, v50
    v_exp_f32 v51, v51
    v_mfma_f32_32x32x16_bf16 v[32:47], v[20:23], v[12:15], v[32:47]
    ds_read_b128 v[16:19], v230 offset:57344
    ds_read_b128 v[20:23], v230 offset:58368
    v_exp_f32 v52, v52
    v_exp_f32 v53, v53
    v_exp_f32 v54, v54
    v_exp_f32 v55, v55
    s_waitcnt lgkmcnt(2)
    v_mfma_f32_32x32x16_bf16 v[80:95], v[24:27], v[64:67], v[80:95]
    v_exp_f32 v56, v56
    v_exp_f32 v57, v57
    v_exp_f32 v58, v58
    v_exp_f32 v59, v59
    v_mfma_f32_32x32x16_bf16 v[80:95], v[28:31], v[68:71], v[80:95]
    ds_read_b32 v234, v233
    v_exp_f32 v60, v60
    v_exp_f32 v61, v61
    v_exp_f32 v62, v62
    v_exp_f32 v63, v63
    v_smfmac_f32_16x16x64_bf16 v[96:99], v[224:227], v[64:71], v228
    ds_read_b128 v[24:27], v230 offset:43008
    ds_read_b128 v[28:31], v230 offset:44032
    v_cvt_pk_bf16_f32 v72, v48, v49
    v_cvt_pk_bf16_f32 v73, v50, v51
    v_cvt_pk_bf16_f32 v74, v52, v53
    v_cvt_pk_bf16_f32 v75, v54, v55
    v_cvt_pk_bf16_f32 v76, v56, v57
    v_cvt_pk_bf16_f32 v77, v58, v59
    v_cvt_pk_bf16_f32 v78, v60, v61
    v_cvt_pk_bf16_f32 v79, v62, v63
    s_setprio 1
    s_waitcnt lgkmcnt(3)
    v_mfma_f32_32x32x16_bf16 v[48:63], v[16:19], v[8:11], 0
    v_exp_f32 v32, v32
    v_exp_f32 v33, v33
    v_exp_f32 v34, v34
    v_exp_f32 v35, v35
    v_mfma_f32_32x32x16_bf16 v[48:63], v[20:23], v[12:15], v[48:63]
    s_waitcnt lgkmcnt(2)
    v_cmp_gt_u32 vcc, s47, v234
    v_exp_f32 v36, v36
    v_exp_f32 v37, v37
    s_cbranch_vccnz L_cnt_spin2
L_cnt_back2:
    ds_read_b128 v[16:19], v229 offset:0
    ds_read_b128 v[20:23], v229 offset:1024
    v_exp_f32 v38, v38
    v_exp_f32 v39, v39
    s_waitcnt lgkmcnt(2)
    v_mfma_f32_32x32x16_bf16 v[80:95], v[24:27], v[72:75], v[80:95]
    v_exp_f32 v40, v40
    s_add_u32 m0, s21, 65536
    v_exp_f32 v41, v41
    buffer_load_dwordx4 v235, s[28:31], s55 offen offset:0 sc1 lds
    v_exp_f32 v42, v42
    v_exp_f32 v43, v43
    v_mfma_f32_32x32x16_bf16 v[80:95], v[28:31], v[76:79], v[80:95]
    buffer_load_dwordx4 v236, s[28:31], s55 offen offset:1024 sc1 lds
    v_exp_f32 v44, v44
    v_exp_f32 v45, v45
    v_exp_f32 v46, v46
    v_exp_f32 v47, v47
    v_smfmac_f32_16x16x64_bf16 v[96:99], v[224:227], v[72:79], v228
    ds_read_b128 v[24:27], v230 offset:51200
    ds_read_b128 v[28:31], v230 offset:52224
    v_cvt_pk_bf16_f32 v64, v32, v33
    v_cvt_pk_bf16_f32 v65, v34, v35
    v_cvt_pk_bf16_f32 v66, v36, v37
    v_cvt_pk_bf16_f32 v67, v38, v39
    v_cvt_pk_bf16_f32 v68, v40, v41
    v_cvt_pk_bf16_f32 v69, v42, v43
    v_cvt_pk_bf16_f32 v70, v44, v45
    v_cvt_pk_bf16_f32 v71, v46, v47
    s_setprio 0
    s_waitcnt lgkmcnt(2)
    v_mfma_f32_32x32x16_bf16 v[32:47], v[16:19], v[8:11], 0
    v_exp_f32 v48, v48
    v_exp_f32 v49, v49
    v_exp_f32 v50, v50
    v_exp_f32 v51, v51
    v_mfma_f32_32x32x16_bf16 v[32:47], v[20:23], v[12:15], v[32:47]
    ds_read_b128 v[16:19], v229 offset:8192
    ds_read_b128 v[20:23], v229 offset:9216
    v_exp_f32 v52, v52
    v_exp_f32 v53, v53
    v_exp_f32 v54, v54
    v_exp_f32 v55, v55
    s_waitcnt lgkmcnt(2)
    v_mfma_f32_32x32x16_bf16 v[80:95], v[24:27], v[64:67], v[80:95]
    v_exp_f32 v56, v56
    v_exp_f32 v57, v57
    buffer_load_dwordx4 v237, s[28:31], s55 offen offset:2048 sc1 lds
    v_exp_f32 v58, v58
    v_exp_f32 v59, v59
    v_mfma_f32_32x32x16_bf16 v[80:95], v[28:31], v[68:71], v[80:95]
    buffer_load_dwordx4 v238, s[28:31], s55 offen offset:3072 sc1 lds
    v_exp_f32 v60, v60
    v_exp_f32 v61, v61
    v_exp_f32 v62, v62
    v_exp_f32 v63, v63
    v_smfmac_f32_16x16x64_bf16 v[96:99], v[224:227], v[64:71], v228
    ds_read_b128 v[24:27], v230 offset:59392
    ds_read_b128 v[28:31], v230 offset:60416
    v_cvt_pk_bf16_f32 v72, v48, v49
    v_cvt_pk_bf16_f32 v73, v50, v51
    v_cvt_pk_bf16_f32 v74, v52, v53
    s_add_u32 s55, s55, s56
    v_cvt_pk_bf16_f32 v75, v54, v55
    v_cvt_pk_bf16_f32 v76, v56, v57
    s_and_b32 s55, s55, s57
    s_cmp_eq_u32 s55, s60
    s_cselect_b32 s36, 16384, 0
    v_cvt_pk_bf16_f32 v77, v58, v59
    v_cvt_pk_bf16_f32 v78, v60, v61
    s_add_u32 s47, s47, 4
    s_add_u32 s55, s55, s36
    v_cvt_pk_bf16_f32 v79, v62, v63
    s_cmp_eq_u32 s47, 64
    s_cbranch_scc1 L_at_tail
    s_setprio 3
    s_waitcnt lgkmcnt(2)
    v_mfma_f32_32x32x16_bf16 v[48:63], v[16:19], v[8:11], 0
    v_exp_f32 v32, v32
    v_exp_f32 v33, v33
    v_exp_f32 v34, v34
    v_exp_f32 v35, v35
    v_mfma_f32_32x32x16_bf16 v[48:63], v[20:23], v[12:15], v[48:63]
    ds_read_b128 v[16:19], v229 offset:16384
    ds_read_b128 v[20:23], v229 offset:17408
    v_exp_f32 v36, v36
    v_exp_f32 v37, v37
    v_exp_f32 v38, v38
    v_exp_f32 v39, v39
    s_waitcnt lgkmcnt(2)
    s_waitcnt vmcnt(4)
    ds_add_u32 v232, v231
    v_mfma_f32_32x32x16_bf16 v[80:95], v[24:27], v[72:75], v[80:95]
    v_exp_f32 v40, v40
    v_exp_f32 v41, v41
    v_exp_f32 v42, v42
    v_exp_f32 v43, v43
    v_mfma_f32_32x32x16_bf16 v[80:95], v[28:31], v[76:79], v[80:95]
    v_exp_f32 v44, v44
    v_exp_f32 v45, v45
    v_exp_f32 v46, v46
    v_exp_f32 v47, v47
    v_smfmac_f32_16x16x64_bf16 v[96:99], v[224:227], v[72:79], v228
    ds_read_b128 v[24:27], v229 offset:2048
    ds_read_b128 v[28:31], v229 offset:3072
    v_cvt_pk_bf16_f32 v64, v32, v33
    v_cvt_pk_bf16_f32 v65, v34, v35
    v_cvt_pk_bf16_f32 v66, v36, v37
    v_cvt_pk_bf16_f32 v67, v38, v39
    v_cvt_pk_bf16_f32 v68, v40, v41
    v_cvt_pk_bf16_f32 v69, v42, v43
    v_cvt_pk_bf16_f32 v70, v44, v45
    v_cvt_pk_bf16_f32 v71, v46, v47
    s_setprio 2
    s_waitcnt lgkmcnt(3)
    v_mfma_f32_32x32x16_bf16 v[32:47], v[16:19], v[8:11], 0
    v_exp_f32 v48, v48
    v_exp_f32 v49, v49
    v_exp_f32 v50, v50
    v_exp_f32 v51, v51
    v_mfma_f32_32x32x16_bf16 v[32:47], v[20:23], v[12:15], v[32:47]
    ds_read_b128 v[16:19], v229 offset:24576
    ds_read_b128 v[20:23], v229 offset:25600
    v_exp_f32 v52, v52
    v_exp_f32 v53, v53
    v_exp_f32 v54, v54
    v_exp_f32 v55, v55
    s_waitcnt lgkmcnt(2)
    v_mfma_f32_32x32x16_bf16 v[80:95], v[24:27], v[64:67], v[80:95]
    v_exp_f32 v56, v56
    v_exp_f32 v57, v57
    v_exp_f32 v58, v58
    v_exp_f32 v59, v59
    v_mfma_f32_32x32x16_bf16 v[80:95], v[28:31], v[68:71], v[80:95]
    ds_read_b32 v234, v233
    v_exp_f32 v60, v60
    v_exp_f32 v61, v61
    v_exp_f32 v62, v62
    v_exp_f32 v63, v63
    v_smfmac_f32_16x16x64_bf16 v[96:99], v[224:227], v[64:71], v228
    ds_read_b128 v[24:27], v229 offset:10240
    ds_read_b128 v[28:31], v229 offset:11264
    v_cvt_pk_bf16_f32 v72, v48, v49
    v_cvt_pk_bf16_f32 v73, v50, v51
    v_cvt_pk_bf16_f32 v74, v52, v53
    v_cvt_pk_bf16_f32 v75, v54, v55
    v_cvt_pk_bf16_f32 v76, v56, v57
    v_cvt_pk_bf16_f32 v77, v58, v59
    v_cvt_pk_bf16_f32 v78, v60, v61
    v_cvt_pk_bf16_f32 v79, v62, v63
    s_setprio 1
    s_waitcnt lgkmcnt(3)
    v_mfma_f32_32x32x16_bf16 v[48:63], v[16:19], v[8:11], 0
    v_exp_f32 v32, v32
    v_exp_f32 v33, v33
    v_exp_f32 v34, v34
    v_exp_f32 v35, v35
    v_mfma_f32_32x32x16_bf16 v[48:63], v[20:23], v[12:15], v[48:63]
    s_waitcnt lgkmcnt(2)
    v_cmp_gt_u32 vcc, s47, v234
    v_exp_f32 v36, v36
    v_exp_f32 v37, v37
    s_cbranch_vccnz L_cnt_spin3
L_cnt_back3:
    ds_read_b128 v[16:19], v229 offset:32768
    ds_read_b128 v[20:23], v229 offset:33792
    v_exp_f32 v38, v38
    v_exp_f32 v39, v39
    s_waitcnt lgkmcnt(2)
    v_mfma_f32_32x32x16_bf16 v[80:95], v[24:27], v[72:75], v[80:95]
    v_exp_f32 v40, v40
    s_add_u32 m0, s21, 98304
    v_exp_f32 v41, v41
    buffer_load_dwordx4 v235, s[28:31], s55 offen offset:0 sc1 lds
    v_exp_f32 v42, v42
    v_exp_f32 v43, v43
    v_mfma_f32_32x32x16_bf16 v[80:95], v[28:31], v[76:79], v[80:95]
    buffer_load_dwordx4 v236, s[28:31], s55 offen offset:1024 sc1 lds
    v_exp_f32 v44, v44
    v_exp_f32 v45, v45
    v_exp_f32 v46, v46
    v_exp_f32 v47, v47
    v_smfmac_f32_16x16x64_bf16 v[96:99], v[224:227], v[72:79], v228
    ds_read_b128 v[24:27], v229 offset:18432
    ds_read_b128 v[28:31], v229 offset:19456
    v_cvt_pk_bf16_f32 v64, v32, v33
    v_cvt_pk_bf16_f32 v65, v34, v35
    v_cvt_pk_bf16_f32 v66, v36, v37
    v_cvt_pk_bf16_f32 v67, v38, v39
    v_cvt_pk_bf16_f32 v68, v40, v41
    v_cvt_pk_bf16_f32 v69, v42, v43
    v_cvt_pk_bf16_f32 v70, v44, v45
    v_cvt_pk_bf16_f32 v71, v46, v47
    s_setprio 0
    s_waitcnt lgkmcnt(2)
    v_mfma_f32_32x32x16_bf16 v[32:47], v[16:19], v[8:11], 0
    v_exp_f32 v48, v48
    v_exp_f32 v49, v49
    v_exp_f32 v50, v50
    v_exp_f32 v51, v51
    v_mfma_f32_32x32x16_bf16 v[32:47], v[20:23], v[12:15], v[32:47]
    ds_read_b128 v[16:19], v229 offset:40960
    ds_read_b128 v[20:23], v229 offset:41984
    v_exp_f32 v52, v52
    v_exp_f32 v53, v53
    v_exp_f32 v54, v54
    v_exp_f32 v55, v55
    s_waitcnt lgkmcnt(2)
    v_mfma_f32_32x32x16_bf16 v[80:95], v[24:27], v[64:67], v[80:95]
    v_exp_f32 v56, v56
    v_exp_f32 v57, v57
    buffer_load_dwordx4 v237, s[28:31], s55 offen offset:2048 sc1 lds
    v_exp_f32 v58, v58
    v_exp_f32 v59, v59
    v_mfma_f32_32x32x16_bf16 v[80:95], v[28:31], v[68:71], v[80:95]
    buffer_load_dwordx4 v238, s[28:31], s55 offen offset:3072 sc1 lds
    v_exp_f32 v60, v60
    v_exp_f32 v61, v61
    v_exp_f32 v62, v62
    v_exp_f32 v63, v63
    v_smfmac_f32_16x16x64_bf16 v[96:99], v[224:227], v[64:71], v228
    ds_read_b128 v[24:27], v229 offset:26624
    ds_read_b128 v[28:31], v229 offset:27648
    v_cvt_pk_bf16_f32 v72, v48, v49
    v_cvt_pk_bf16_f32 v73, v50, v51
    v_cvt_pk_bf16_f32 v74, v52, v53
    s_add_u32 s55, s55, s56
    v_cvt_pk_bf16_f32 v75, v54, v55
    v_cvt_pk_bf16_f32 v76, v56, v57
    s_and_b32 s55, s55, s57
    s_cmp_eq_u32 s55, s60
    s_cselect_b32 s36, 16384, 0
    v_cvt_pk_bf16_f32 v77, v58, v59
    v_cvt_pk_bf16_f32 v78, v60, v61
    s_add_u32 s47, s47, 4
    s_add_u32 s55, s55, s36
    v_cvt_pk_bf16_f32 v79, v62, v63
    s_cmp_eq_u32 s47, 52
    s_cbranch_scc0 L_at_loop
    s_lshl_b32 s39, s11, 7
    s_sub_u32 s36, 0x200000, s39
    s_add_u32 s28, s40, s39
    s_addc_u32 s29, s41, 0
    s_mov_b32 s30, s36
    s_mov_b32 s31, 0x20000
    s_mov_b32 s55, 0
    s_mov_b32 s56, 524288
    s_mov_b32 s57, -1
    s_mov_b32 s60, -1
    v_lshrrev_b32 v4, 3, v2
    v_lshlrev_b32 v4, 11, v4
    v_and_b32 v5, 7, v2
    v_lshrrev_b32 v6, 4, v2
    v_and_b32 v6, 1, v6
    v_lshlrev_b32 v6, 2, v6
    v_xor_b32 v5, v5, v6
    v_lshlrev_b32 v5, 4, v5
    v_add_u32 v4, v4, v5
    s_lshl_b32 s36, s21, 4
    v_add_u32 v4, s36, v4
    v_add_u32 v235, 0, v4
    v_add_u32 v236, 15360, v4
    v_add_u32 v237, 30720, v4
    v_add_u32 v238, 46080, v4
    s_branch L_at_loop
L_cnt_spin0:
    s_mov_b32 s39, 0
L_cnt_spin20:
    ds_read_b32 v234, v233
    s_waitcnt lgkmcnt(0)
    v_readfirstlane_b32 s36, v234
    s_add_u32 s39, s39, 1
    s_cmp_ge_u32 s39, 640000
    s_cbranch_scc1 L_cnt_back0
    s_cmp_ge_u32 s36, s47
    s_cbranch_scc0 L_cnt_spin20
    s_branch L_cnt_back0
L_cnt_spin1:
    s_mov_b32 s39, 0
L_cnt_spin21:
    ds_read_b32 v234, v233
    s_waitcnt lgkmcnt(0)
    v_readfirstlane_b32 s36, v234
    s_add_u32 s39, s39, 1
    s_cmp_ge_u32 s39, 640000
    s_cbranch_scc1 L_cnt_back1
    s_cmp_ge_u32 s36, s47
    s_cbranch_scc0 L_cnt_spin21
    s_branch L_cnt_back1
L_cnt_spin2:
    s_mov_b32 s39, 0
L_cnt_spin22:
    ds_read_b32 v234, v233
    s_waitcnt lgkmcnt(0)
    v_readfirstlane_b32 s36, v234
    s_add_u32 s39, s39, 1
    s_cmp_ge_u32 s39, 640000
    s_cbranch_scc1 L_cnt_back2
    s_cmp_ge_u32 s36, s47
    s_cbranch_scc0 L_cnt_spin22
    s_branch L_cnt_back2
L_cnt_spin3:
    s_mov_b32 s39, 0
L_cnt_spin23:
    ds_read_b32 v234, v233
    s_waitcnt lgkmcnt(0)
    v_readfirstlane_b32 s36, v234
    s_add_u32 s39, s39, 1
    s_cmp_ge_u32 s39, 640000
    s_cbranch_scc1 L_cnt_back3
    s_cmp_ge_u32 s36, s47
    s_cbranch_scc0 L_cnt_spin23
    s_branch L_cnt_back3
L_at_tail:
    s_setprio 0
    s_waitcnt lgkmcnt(0)
    v_mfma_f32_32x32x16_bf16 v[80:95], v[24:27], v[72:75], v[80:95]
    v_mfma_f32_32x32x16_bf16 v[80:95], v[28:31], v[76:79], v[80:95]
    v_smfmac_f32_16x16x64_bf16 v[96:99], v[224:227], v[72:79], v228
    s_nop 8
    s_nop 7
    v_add_f32 v96, v96, v97
    v_mov_b32 v4, 729808896
    v_mov_b32 v5, 1400897536
    v_cmp_nge_f32 vcc, v96, v4
    v_cmp_nle_f32 s[44:45], v96, v5
    s_or_b64 s[44:45], s[44:45], vcc
    v_add_f32 v6, abs(v80), abs(v81)
    v_add_f32 v7, abs(v82), abs(v83)
    v_add_f32 v6, v6, abs(v84)
    v_add_f32 v7, v7, abs(v85)
    v_add_f32 v6, v6, abs(v86)
    v_add_f32 v7, v7, abs(v87)
    v_add_f32 v6, v6, abs(v88)
    v_add_f32 v7, v7, abs(v89)
    v_add_f32 v6, v6, abs(v90)
    v_add_f32 v7, v7, abs(v91)
    v_add_f32 v6, v6, abs(v92)
    v_add_f32 v7, v7, abs(v93)
    v_add_f32 v6, v6, abs(v94)
    v_add_f32 v7, v7, abs(v95)
    v_mov_b32 v5, 1904214016
    v_add_f32 v6, v6, v7
    v_cmp_nlt_f32 vcc, v6, v5
    s_or_b64 s[44:45], s[44:45], vcc
    s_cmp_lg_u64 s[44:45], 0
    s_cbranch_scc1 L_at_slow
L_at_fin:
    v_rcp_f32 v4, v96
    s_nop 0
    v_mul_f32 v80, v80, v4
    v_mul_f32 v81, v81, v4
    v_mul_f32 v82, v82, v4
    v_mul_f32 v83, v83, v4
    v_mul_f32 v84, v84, v4
    v_mul_f32 v85, v85, v4
    v_mul_f32 v86, v86, v4
    v_mul_f32 v87, v87, v4
    v_mul_f32 v88, v88, v4
    v_mul_f32 v89, v89, v4
    v_mul_f32 v90, v90, v4
    v_mul_f32 v91, v91, v4
    v_mul_f32 v92, v92, v4
    v_mul_f32 v93, v93, v4
    v_mul_f32 v94, v94, v4
    v_mul_f32 v95, v95, v4
    v_cvt_pk_bf16_f32 v64, v80, v81
    v_cvt_pk_bf16_f32 v65, v82, v83
    v_cvt_pk_bf16_f32 v66, v84, v85
    v_cvt_pk_bf16_f32 v67, v86, v87
    v_cvt_pk_bf16_f32 v68, v88, v89
    v_cvt_pk_bf16_f32 v69, v90, v91
    v_cvt_pk_bf16_f32 v70, v92, v93
    v_cvt_pk_bf16_f32 v71, v94, v95
    s_lshl_b32 s19, s18, 6
    s_lshl_b32 s36, s17, 1
    s_add_u32 s19, s19, s36
    s_lshl_b32 s19, s19, 10
    s_add_u32 s19, s19, 8388608
    buffer_store_dwordx4 v[64:67], v3, s[24:27], s19 offen sc1
    buffer_store_dwordx4 v[68:71], v3, s[24:27], s19 offen offset:1024 sc1
    s_mov_b32 s32, s42
    s_mov_b32 s33, s43
    s_mov_b32 s34, 4194304
    s_mov_b32 s35, 0x20000
    s_lshl_b32 s36, s11, 14
    s_lshl_b32 s37, s16, 12
    s_add_u32 s36, s36, s37
    s_lshl_b32 s37, s10, 8
    s_add_u32 s36, s36, s37
    s_lshl_b32 s37, s15, 7
    s_add_u32 s36, s36, s37
    s_add_u32 s36, s36, 12713984
    v_mov_b32 v5, s36
    v_mov_b32 v6, s46
    s_waitcnt vmcnt(0)
    s_mov_b64 exec, 1
    buffer_store_dword v6, v5, s[24:27], 0 offen sc1
    s_mov_b64 exec, -1
    s_barrier
    s_add_u32 m0, s21, 98304
    s_lshl_b32 s36, s14, 12
    s_add_u32 s36, s36, 131072
    buffer_load_dwordx4 v235, s[28:31], s55 offen offset:0 lds
    buffer_load_dwordx4 v236, s[28:31], s55 offen offset:1024 lds
    buffer_load_dwordx4 v237, s[28:31], s55 offen offset:2048 lds
    buffer_load_dwordx4 v238, s[28:31], s55 offen offset:3072 lds
    v_add_u32 v196, s36, v3
    v_mov_b32 v200, -1
    v_mov_b32 v201, -1
    v_mov_b32 v202, -1
    v_mov_b32 v203, -1
    ds_write_b128 v196, v[200:203] offset:3072
    s_xor_b32 s36, s14, 4
    s_lshl_b32 s36, s36, 12
    s_add_u32 s36, s36, 131072
    v_add_u32 v197, s36, v3
    v_lshrrev_b32 v5, 5, v2
    v_and_b32 v6, 15, v2
    v_lshrrev_b32 v6, 2, v6
    v_lshlrev_b32 v7, 2, v5
    v_add_u32 v7, v7, v6
    v_lshlrev_b32 v7, 7, v7
    v_lshrrev_b32 v8, 4, v2
    v_and_b32 v8, 1, v8
    v_lshlrev_b32 v8, 1, v8
    v_and_b32 v9, 3, v2
    v_lshrrev_b32 v10, 1, v9
    v_add_u32 v8, v8, v10
    v_lshrrev_b32 v10, 1, v6
    v_lshlrev_b32 v10, 2, v10
    v_xor_b32 v8, v8, v10
    v_lshlrev_b32 v8, 4, v8
    v_add_u32 v7, v7, v8
    v_and_b32 v9, 1, v9
    v_lshlrev_b32 v9, 3, v9
    v_add_u32 v7, v7, v9
    s_lshl_b32 s36, s15, 16
    s_add_u32 s36, s36, 0
    v_add_u32 v12, s36, v7
    v_xor_b32 v13, 64, v12
    v_mov_b32 v16, 0
    v_mov_b32 v17, 0
    v_mov_b32 v18, 0
    v_mov_b32 v19, 0
    v_mov_b32 v20, 0
    v_mov_b32 v21, 0
    v_mov_b32 v22, 0
    v_mov_b32 v23, 0
    v_mov_b32 v24, 0
    v_mov_b32 v25, 0
    v_mov_b32 v26, 0
    v_mov_b32 v27, 0
    v_mov_b32 v28, 0
    v_mov_b32 v29, 0
    v_mov_b32 v30, 0
    v_mov_b32 v31, 0
    v_mov_b32 v32, 0
    v_mov_b32 v33, 0
    v_mov_b32 v34, 0
    v_mov_b32 v35, 0
    v_mov_b32 v36, 0
    v_mov_b32 v37, 0
    v_mov_b32 v38, 0
    v_mov_b32 v39, 0
    v_mov_b32 v40, 0
    v_mov_b32 v41, 0
    v_mov_b32 v42, 0
    v_mov_b32 v43, 0
    v_mov_b32 v44, 0
    v_mov_b32 v45, 0
    v_mov_b32 v46, 0
    v_mov_b32 v47, 0
    v_mov_b32 v204, 0
    v_mov_b32 v205, 0
    v_mov_b32 v206, 0
    v_mov_b32 v207, 0
    v_mov_b32 v208, 0
    v_mov_b32 v209, 0
    v_mov_b32 v210, 0
    v_mov_b32 v211, 0
    v_mov_b32 v212, 0
    v_mov_b32 v213, 0
    v_mov_b32 v214, 0
    v_mov_b32 v215, 0
    v_mov_b32 v216, 0
    v_mov_b32 v217, 0
    v_mov_b32 v218, 0
    v_mov_b32 v219, 0
    v_mov_b32 v220, 0
    v_mov_b32 v221, 0
    v_mov_b32 v222, 0
    v_mov_b32 v223, 0
    v_mov_b32 v224, 0
    v_mov_b32 v225, 0
    v_mov_b32 v226, 0
    v_mov_b32 v227, 0
    v_mov_b32 v228, 0
    v_mov_b32 v229, 0
    v_mov_b32 v230, 0
    v_mov_b32 v231, 0
    v_mov_b32 v232, 0
    v_mov_b32 v233, 0
    v_mov_b32 v234, 0
    v_mov_b32 v235, 0
    s_lshl_b32 s36, s10, 14
    s_lshl_b32 s37, s16, 12
    s_add_u32 s36, s36, s37
    s_lshl_b32 s37, s15, 11
    s_add_u32 s36, s36, s37
    s_add_u32 s36, s36, 12713984
    v_and_b32 v4, 15, v2
    v_lshlrev_b32 v4, 7, v4
    v_add_u32 v4, s36, v4
    s_lshl_b32 s36, s10, 2
    s_add_u32 s36, s36, s16
    s_lshl_b32 s36, s36, 6
    s_lshl_b32 s37, s15, 5
    s_add_u32 s36, s36, s37
    s_lshl_b32 s36, s36, 10
    s_add_u32 s36, s36, 8388608
    s_and_b32 s50, s11, 1
    s_lshl_b32 s50, s50, 2
    s_lshl_b32 s51, s50, 1
    s_sub_u32 s52, 16, s51
    s_mov_b32 s48, 0
    s_mov_b32 s54, 0
    s_mov_b32 s47, 0
    s_mov_b32 s49, 0
    s_waitcnt vmcnt(0) lgkmcnt(0)
    s_barrier
    buffer_load_dword v5, v4, s[24:27], 0 offen sc1
    s_mov_b32 s58, 0
    s_mov_b32 s59, 0
    s_mov_b32 s57, 0
L_og_round:
    s_bcnt1_i32_b32 s53, s49
    s_cmp_ge_u32 s53, 8
    s_cbranch_scc1 L_og_w8
    s_cmp_ge_u32 s53, 7
    s_cbranch_scc1 L_og_w7
    s_cmp_ge_u32 s53, 6
    s_cbranch_scc1 L_og_w6
    s_cmp_ge_u32 s53, 5
    s_cbranch_scc1 L_og_w5
    s_cmp_ge_u32 s53, 4
    s_cbranch_scc1 L_og_w4
    s_cmp_ge_u32 s53, 3
    s_cbranch_scc1 L_og_w3
    s_cmp_ge_u32 s53, 2
    s_cbranch_scc1 L_og_w2
    s_cmp_ge_u32 s53, 1
    s_cbranch_scc1 L_og_w1
    s_waitcnt vmcnt(0)
    s_branch L_og_wd
L_og_w1:
    s_waitcnt vmcnt(4)
    s_branch L_og_wd
L_og_w2:
    s_waitcnt vmcnt(8)
    s_branch L_og_wd
L_og_w3:
    s_waitcnt vmcnt(12)
    s_branch L_og_wd
L_og_w4:
    s_waitcnt vmcnt(16)
    s_branch L_og_wd
L_og_w5:
    s_waitcnt vmcnt(20)
    s_branch L_og_wd
L_og_w6:
    s_waitcnt vmcnt(24)
    s_branch L_og_wd
L_og_w7:
    s_waitcnt vmcnt(28)
    s_branch L_og_wd
L_og_w8:
    s_waitcnt vmcnt(32)
L_og_wd:
    s_mov_b32 s48, s58
    v_cmp_eq_u32 vcc, s46, v5
    s_add_u32 s47, s47, 1
    s_lshr_b32 s49, vcc_lo, 1
    s_and_b32 s49, s49, vcc_lo
    s_and_b32 s49, s49, 0x5555
    s_lshr_b32 s53, s49, s51
    s_lshl_b32 s49, s49, s52
    s_or_b32 s49, s49, s53
    s_and_b32 s49, s49, 0x5555
    s_cmp_ge_u32 s47, 40000
    s_cselect_b32 s49, 0x5555, s49
    s_andn2_b32 s49, s49, s59
    s_cmp_eq_u32 s49, 0x5555
    s_cbranch_scc1 L_og_fast
    s_mov_b32 s58, s59
    s_or_b32 s59, s59, s49
    s_cmp_eq_u32 s59, 0x5555
    s_cselect_b32 s57, 1, 0
    s_cbranch_scc1 L_og_nopoll
    s_cmp_eq_u32 s49, 0
    s_cbranch_scc0 L_og_poll
    s_sleep 2
L_og_poll:
    buffer_load_dword v5, v4, s[24:27], 0 offen sc1
L_og_nopoll:
    s_bitcmp1_b32 s49, 0
    s_cbranch_scc0 L_og_nl0
    s_add_u32 s53, s50, 0
    s_and_b32 s53, s53, 7
    s_lshl_b32 s53, s53, 12
    s_add_u32 s53, s53, s36
    buffer_load_dwordx4 v[64:67], v3, s[24:27], s53 offen offset:0 sc1
    buffer_load_dwordx4 v[68:71], v3, s[24:27], s53 offen offset:1024 sc1
    buffer_load_dwordx4 v[72:75], v3, s[24:27], s53 offen offset:2048 sc1
    buffer_load_dwordx4 v[76:79], v3, s[24:27], s53 offen offset:3072 sc1
L_og_nl0:
    s_bitcmp1_b32 s49, 2
    s_cbranch_scc0 L_og_nl1
    s_add_u32 s53, s50, 1
    s_and_b32 s53, s53, 7
    s_lshl_b32 s53, s53, 12
    s_add_u32 s53, s53, s36
    buffer_load_dwordx4 v[80:83], v3, s[24:27], s53 offen offset:0 sc1
    buffer_load_dwordx4 v[84:87], v3, s[24:27], s53 offen offset:1024 sc1
    buffer_load_dwordx4 v[88:91], v3, s[24:27], s53 offen offset:2048 sc1
    buffer_load_dwordx4 v[92:95], v3, s[24:27], s53 offen offset:3072 sc1
L_og_nl1:
    s_bitcmp1_b32 s49, 4
    s_cbranch_scc0 L_og_nl2
    s_add_u32 s53, s50, 2
    s_and_b32 s53, s53, 7
    s_lshl_b32 s53, s53, 12
    s_add_u32 s53, s53, s36
    buffer_load_dwordx4 v[96:99], v3, s[24:27], s53 offen offset:0 sc1
    buffer_load_dwordx4 v[100:103], v3, s[24:27], s53 offen offset:1024 sc1
    buffer_load_dwordx4 v[104:107], v3, s[24:27], s53 offen offset:2048 sc1
    buffer_load_dwordx4 v[108:111], v3, s[24:27], s53 offen offset:3072 sc1
L_og_nl2:
    s_bitcmp1_b32 s49, 6
    s_cbranch_scc0 L_og_nl3
    s_add_u32 s53, s50, 3
    s_and_b32 s53, s53, 7
    s_lshl_b32 s53, s53, 12
    s_add_u32 s53, s53, s36
    buffer_load_dwordx4 v[112:115], v3, s[24:27], s53 offen offset:0 sc1
    buffer_load_dwordx4 v[116:119], v3, s[24:27], s53 offen offset:1024 sc1
    buffer_load_dwordx4 v[120:123], v3, s[24:27], s53 offen offset:2048 sc1
    buffer_load_dwordx4 v[124:127], v3, s[24:27], s53 offen offset:3072 sc1
L_og_nl3:
    s_bitcmp1_b32 s49, 8
    s_cbranch_scc0 L_og_nl4
    s_add_u32 s53, s50, 4
    s_and_b32 s53, s53, 7
    s_lshl_b32 s53, s53, 12
    s_add_u32 s53, s53, s36
    buffer_load_dwordx4 v[128:131], v3, s[24:27], s53 offen offset:0 sc1
    buffer_load_dwordx4 v[132:135], v3, s[24:27], s53 offen offset:1024 sc1
    buffer_load_dwordx4 v[136:139], v3, s[24:27], s53 offen offset:2048 sc1
    buffer_load_dwordx4 v[140:143], v3, s[24:27], s53 offen offset:3072 sc1
L_og_nl4:
    s_bitcmp1_b32 s49, 10
    s_cbranch_scc0 L_og_nl5
    s_add_u32 s53, s50, 5
    s_and_b32 s53, s53, 7
    s_lshl_b32 s53, s53, 12
    s_add_u32 s53, s53, s36
    buffer_load_dwordx4 v[144:147], v3, s[24:27], s53 offen offset:0 sc1
    buffer_load_dwordx4 v[148:151], v3, s[24:27], s53 offen offset:1024 sc1
    buffer_load_dwordx4 v[152:155], v3, s[24:27], s53 offen offset:2048 sc1
    buffer_load_dwordx4 v[156:159], v3, s[24:27], s53 offen offset:3072 sc1
L_og_nl5:
    s_bitcmp1_b32 s49, 12
    s_cbranch_scc0 L_og_nl6
    s_add_u32 s53, s50, 6
    s_and_b32 s53, s53, 7
    s_lshl_b32 s53, s53, 12
    s_add_u32 s53, s53, s36
    buffer_load_dwordx4 v[160:163], v3, s[24:27], s53 offen offset:0 sc1
    buffer_load_dwordx4 v[164:167], v3, s[24:27], s53 offen offset:1024 sc1
    buffer_load_dwordx4 v[168:171], v3, s[24:27], s53 offen offset:2048 sc1
    buffer_load_dwordx4 v[172:175], v3, s[24:27], s53 offen offset:3072 sc1
L_og_nl6:
    s_bitcmp1_b32 s49, 14
    s_cbranch_scc0 L_og_nl7
    s_add_u32 s53, s50, 7
    s_and_b32 s53, s53, 7
    s_lshl_b32 s53, s53, 12
    s_add_u32 s53, s53, s36
    buffer_load_dwordx4 v[176:179], v3, s[24:27], s53 offen offset:0 sc1
    buffer_load_dwordx4 v[180:183], v3, s[24:27], s53 offen offset:1024 sc1
    buffer_load_dwordx4 v[184:187], v3, s[24:27], s53 offen offset:2048 sc1
    buffer_load_dwordx4 v[188:191], v3, s[24:27], s53 offen offset:3072 sc1
L_og_nl7:
L_og_pass:
    s_bitcmp1_b32 s54, 0
    s_cbranch_scc1 L_og_nm0
    s_bitcmp1_b32 s48, 0
    s_cbranch_scc0 L_og_chainB
    s_bitset1_b32 s54, 0
    s_add_u32 s53, s50, 0
    s_and_b32 s53, s53, 7
    s_lshl_b32 s53, s53, 13
    v_add_u32 v14, s53, v12
    v_add_u32 v15, s53, v13
    ds_read_b64_tr_b16 v[48:49], v14 offset:0
    ds_read_b64_tr_b16 v[50:51], v14 offset:1024
    ds_read_b64_tr_b16 v[52:53], v15 offset:0
    ds_read_b64_tr_b16 v[54:55], v15 offset:1024
    ds_read_b64_tr_b16 v[56:57], v14 offset:2048
    ds_read_b64_tr_b16 v[58:59], v14 offset:3072
    ds_read_b64_tr_b16 v[60:61], v15 offset:2048
    ds_read_b64_tr_b16 v[62:63], v15 offset:3072
    s_waitcnt lgkmcnt(4)
    v_mfma_f32_32x32x16_bf16 v[16:31], v[48:51], v[64:67], v[16:31]
    v_mfma_f32_32x32x16_bf16 v[32:47], v[52:55], v[64:67], v[32:47]
    ds_read_b64_tr_b16 v[48:49], v14 offset:4096
    ds_read_b64_tr_b16 v[50:51], v14 offset:5120
    ds_read_b64_tr_b16 v[52:53], v15 offset:4096
    ds_read_b64_tr_b16 v[54:55], v15 offset:5120
    s_waitcnt lgkmcnt(4)
    v_mfma_f32_32x32x16_bf16 v[16:31], v[56:59], v[68:71], v[16:31]
    v_mfma_f32_32x32x16_bf16 v[32:47], v[60:63], v[68:71], v[32:47]
    ds_read_b64_tr_b16 v[56:57], v14 offset:6144
    ds_read_b64_tr_b16 v[58:59], v14 offset:7168
    ds_read_b64_tr_b16 v[60:61], v15 offset:6144
    ds_read_b64_tr_b16 v[62:63], v15 offset:7168
    s_waitcnt lgkmcnt(4)
    v_mfma_f32_32x32x16_bf16 v[16:31], v[48:51], v[72:75], v[16:31]
    v_mfma_f32_32x32x16_bf16 v[32:47], v[52:55], v[72:75], v[32:47]
    s_waitcnt lgkmcnt(0)
    v_mfma_f32_32x32x16_bf16 v[16:31], v[56:59], v[76:79], v[16:31]
    v_mfma_f32_32x32x16_bf16 v[32:47], v[60:63], v[76:79], v[32:47]
L_og_nm0:
    s_bitcmp1_b32 s54, 2
    s_cbranch_scc1 L_og_nm1
    s_bitcmp1_b32 s48, 2
    s_cbranch_scc0 L_og_chainB
    s_bitset1_b32 s54, 2
    s_add_u32 s53, s50, 1
    s_and_b32 s53, s53, 7
    s_lshl_b32 s53, s53, 13
    v_add_u32 v14, s53, v12
    v_add_u32 v15, s53, v13
    ds_read_b64_tr_b16 v[48:49], v14 offset:0
    ds_read_b64_tr_b16 v[50:51], v14 offset:1024
    ds_read_b64_tr_b16 v[52:53], v15 offset:0
    ds_read_b64_tr_b16 v[54:55], v15 offset:1024
    ds_read_b64_tr_b16 v[56:57], v14 offset:2048
    ds_read_b64_tr_b16 v[58:59], v14 offset:3072
    ds_read_b64_tr_b16 v[60:61], v15 offset:2048
    ds_read_b64_tr_b16 v[62:63], v15 offset:3072
    s_waitcnt lgkmcnt(4)
    v_mfma_f32_32x32x16_bf16 v[16:31], v[48:51], v[80:83], v[16:31]
    v_mfma_f32_32x32x16_bf16 v[32:47], v[52:55], v[80:83], v[32:47]
    ds_read_b64_tr_b16 v[48:49], v14 offset:4096
    ds_read_b64_tr_b16 v[50:51], v14 offset:5120
    ds_read_b64_tr_b16 v[52:53], v15 offset:4096
    ds_read_b64_tr_b16 v[54:55], v15 offset:5120
    s_waitcnt lgkmcnt(4)
    v_mfma_f32_32x32x16_bf16 v[16:31], v[56:59], v[84:87], v[16:31]
    v_mfma_f32_32x32x16_bf16 v[32:47], v[60:63], v[84:87], v[32:47]
    ds_read_b64_tr_b16 v[56:57], v14 offset:6144
    ds_read_b64_tr_b16 v[58:59], v14 offset:7168
    ds_read_b64_tr_b16 v[60:61], v15 offset:6144
    ds_read_b64_tr_b16 v[62:63], v15 offset:7168
    s_waitcnt lgkmcnt(4)
    v_mfma_f32_32x32x16_bf16 v[16:31], v[48:51], v[88:91], v[16:31]
    v_mfma_f32_32x32x16_bf16 v[32:47], v[52:55], v[88:91], v[32:47]
    s_waitcnt lgkmcnt(0)
    v_mfma_f32_32x32x16_bf16 v[16:31], v[56:59], v[92:95], v[16:31]
    v_mfma_f32_32x32x16_bf16 v[32:47], v[60:63], v[92:95], v[32:47]
L_og_nm1:
    s_bitcmp1_b32 s54, 4
    s_cbranch_scc1 L_og_nm2
    s_bitcmp1_b32 s48, 4
    s_cbranch_scc0 L_og_chainB
    s_bitset1_b32 s54, 4
    s_add_u32 s53, s50, 2
    s_and_b32 s53, s53, 7
    s_lshl_b32 s53, s53, 13
    v_add_u32 v14, s53, v12
    v_add_u32 v15, s53, v13
    ds_read_b64_tr_b16 v[48:49], v14 offset:0
    ds_read_b64_tr_b16 v[50:51], v14 offset:1024
    ds_read_b64_tr_b16 v[52:53], v15 offset:0
    ds_read_b64_tr_b16 v[54:55], v15 offset:1024
    ds_read_b64_tr_b16 v[56:57], v14 offset:2048
    ds_read_b64_tr_b16 v[58:59], v14 offset:3072
    ds_read_b64_tr_b16 v[60:61], v15 offset:2048
    ds_read_b64_tr_b16 v[62:63], v15 offset:3072
    s_waitcnt lgkmcnt(4)
    v_mfma_f32_32x32x16_bf16 v[16:31], v[48:51], v[96:99], v[16:31]
    v_mfma_f32_32x32x16_bf16 v[32:47], v[52:55], v[96:99], v[32:47]
    ds_read_b64_tr_b16 v[48:49], v14 offset:4096
    ds_read_b64_tr_b16 v[50:51], v14 offset:5120
    ds_read_b64_tr_b16 v[52:53], v15 offset:4096
    ds_read_b64_tr_b16 v[54:55], v15 offset:5120
    s_waitcnt lgkmcnt(4)
    v_mfma_f32_32x32x16_bf16 v[16:31], v[56:59], v[100:103], v[16:31]
    v_mfma_f32_32x32x16_bf16 v[32:47], v[60:63], v[100:103], v[32:47]
    ds_read_b64_tr_b16 v[56:57], v14 offset:6144
    ds_read_b64_tr_b16 v[58:59], v14 offset:7168
    ds_read_b64_tr_b16 v[60:61], v15 offset:6144
    ds_read_b64_tr_b16 v[62:63], v15 offset:7168
    s_waitcnt lgkmcnt(4)
    v_mfma_f32_32x32x16_bf16 v[16:31], v[48:51], v[104:107], v[16:31]
    v_mfma_f32_32x32x16_bf16 v[32:47], v[52:55], v[104:107], v[32:47]
    s_waitcnt lgkmcnt(0)
    v_mfma_f32_32x32x16_bf16 v[16:31], v[56:59], v[108:111], v[16:31]
    v_mfma_f32_32x32x16_bf16 v[32:47], v[60:63], v[108:111], v[32:47]
L_og_nm2:
    s_bitcmp1_b32 s54, 6
    s_cbranch_scc1 L_og_nm3
    s_bitcmp1_b32 s48, 6
    s_cbranch_scc0 L_og_chainB
    s_bitset1_b32 s54, 6
    s_add_u32 s53, s50, 3
    s_and_b32 s53, s53, 7
    s_lshl_b32 s53, s53, 13
    v_add_u32 v14, s53, v12
    v_add_u32 v15, s53, v13
    ds_read_b64_tr_b16 v[48:49], v14 offset:0
    ds_read_b64_tr_b16 v[50:51], v14 offset:1024
    ds_read_b64_tr_b16 v[52:53], v15 offset:0
    ds_read_b64_tr_b16 v[54:55], v15 offset:1024
    ds_read_b64_tr_b16 v[56:57], v14 offset:2048
    ds_read_b64_tr_b16 v[58:59], v14 offset:3072
    ds_read_b64_tr_b16 v[60:61], v15 offset:2048
    ds_read_b64_tr_b16 v[62:63], v15 offset:3072
    s_waitcnt lgkmcnt(4)
    v_mfma_f32_32x32x16_bf16 v[16:31], v[48:51], v[112:115], v[16:31]
    v_mfma_f32_32x32x16_bf16 v[32:47], v[52:55], v[112:115], v[32:47]
    ds_read_b64_tr_b16 v[48:49], v14 offset:4096
    ds_read_b64_tr_b16 v[50:51], v14 offset:5120
    ds_read_b64_tr_b16 v[52:53], v15 offset:4096
    ds_read_b64_tr_b16 v[54:55], v15 offset:5120
    s_waitcnt lgkmcnt(4)
    v_mfma_f32_32x32x16_bf16 v[16:31], v[56:59], v[116:119], v[16:31]
    v_mfma_f32_32x32x16_bf16 v[32:47], v[60:63], v[116:119], v[32:47]
    ds_read_b64_tr_b16 v[56:57], v14 offset:6144
    ds_read_b64_tr_b16 v[58:59], v14 offset:7168
    ds_read_b64_tr_b16 v[60:61], v15 offset:6144
    ds_read_b64_tr_b16 v[62:63], v15 offset:7168
    s_waitcnt lgkmcnt(4)
    v_mfma_f32_32x32x16_bf16 v[16:31], v[48:51], v[120:123], v[16:31]
    v_mfma_f32_32x32x16_bf16 v[32:47], v[52:55], v[120:123], v[32:47]
    s_waitcnt lgkmcnt(0)
    v_mfma_f32_32x32x16_bf16 v[16:31], v[56:59], v[124:127], v[16:31]
    v_mfma_f32_32x32x16_bf16 v[32:47], v[60:63], v[124:127], v[32:47]
L_og_nm3:
L_og_chainB:
    s_bitcmp1_b32 s54, 8
    s_cbranch_scc1 L_og_nm4
    s_bitcmp1_b32 s48, 8
    s_cbranch_scc0 L_og_next
    s_bitset1_b32 s54, 8
    s_add_u32 s53, s50, 4
    s_and_b32 s53, s53, 7
    s_lshl_b32 s53, s53, 13
    v_add_u32 v14, s53, v12
    v_add_u32 v15, s53, v13
    ds_read_b64_tr_b16 v[48:49], v14 offset:0
    ds_read_b64_tr_b16 v[50:51], v14 offset:1024
    ds_read_b64_tr_b16 v[52:53], v15 offset:0
    ds_read_b64_tr_b16 v[54:55], v15 offset:1024
    ds_read_b64_tr_b16 v[56:57], v14 offset:2048
    ds_read_b64_tr_b16 v[58:59], v14 offset:3072
    ds_read_b64_tr_b16 v[60:61], v15 offset:2048
    ds_read_b64_tr_b16 v[62:63], v15 offset:3072
    s_waitcnt lgkmcnt(4)
    v_mfma_f32_32x32x16_bf16 v[204:219], v[48:51], v[128:131], v[204:219]
    v_mfma_f32_32x32x16_bf16 v[220:235], v[52:55], v[128:131], v[220:235]
    ds_read_b64_tr_b16 v[48:49], v14 offset:4096
    ds_read_b64_tr_b16 v[50:51], v14 offset:5120
    ds_read_b64_tr_b16 v[52:53], v15 offset:4096
    ds_read_b64_tr_b16 v[54:55], v15 offset:5120
    s_waitcnt lgkmcnt(4)
    v_mfma_f32_32x32x16_bf16 v[204:219], v[56:59], v[132:135], v[204:219]
    v_mfma_f32_32x32x16_bf16 v[220:235], v[60:63], v[132:135], v[220:235]
    ds_read_b64_tr_b16 v[56:57], v14 offset:6144
    ds_read_b64_tr_b16 v[58:59], v14 offset:7168
    ds_read_b64_tr_b16 v[60:61], v15 offset:6144
    ds_read_b64_tr_b16 v[62:63], v15 offset:7168
    s_waitcnt lgkmcnt(4)
    v_mfma_f32_32x32x16_bf16 v[204:219], v[48:51], v[136:139], v[204:219]
    v_mfma_f32_32x32x16_bf16 v[220:235], v[52:55], v[136:139], v[220:235]
    s_waitcnt lgkmcnt(0)
    v_mfma_f32_32x32x16_bf16 v[204:219], v[56:59], v[140:143], v[204:219]
    v_mfma_f32_32x32x16_bf16 v[220:235], v[60:63], v[140:143], v[220:235]
L_og_nm4:
    s_bitcmp1_b32 s54, 10
    s_cbranch_scc1 L_og_nm5
    s_bitcmp1_b32 s48, 10
    s_cbranch_scc0 L_og_next
    s_bitset1_b32 s54, 10
    s_add_u32 s53, s50, 5
    s_and_b32 s53, s53, 7
    s_lshl_b32 s53, s53, 13
    v_add_u32 v14, s53, v12
    v_add_u32 v15, s53, v13
    ds_read_b64_tr_b16 v[48:49], v14 offset:0
    ds_read_b64_tr_b16 v[50:51], v14 offset:1024
    ds_read_b64_tr_b16 v[52:53], v15 offset:0
    ds_read_b64_tr_b16 v[54:55], v15 offset:1024
    ds_read_b64_tr_b16 v[56:57], v14 offset:2048
    ds_read_b64_tr_b16 v[58:59], v14 offset:3072
    ds_read_b64_tr_b16 v[60:61], v15 offset:2048
    ds_read_b64_tr_b16 v[62:63], v15 offset:3072
    s_waitcnt lgkmcnt(4)
    v_mfma_f32_32x32x16_bf16 v[204:219], v[48:51], v[144:147], v[204:219]
    v_mfma_f32_32x32x16_bf16 v[220:235], v[52:55], v[144:147], v[220:235]
    ds_read_b64_tr_b16 v[48:49], v14 offset:4096
    ds_read_b64_tr_b16 v[50:51], v14 offset:5120
    ds_read_b64_tr_b16 v[52:53], v15 offset:4096
    ds_read_b64_tr_b16 v[54:55], v15 offset:5120
    s_waitcnt lgkmcnt(4)
    v_mfma_f32_32x32x16_bf16 v[204:219], v[56:59], v[148:151], v[204:219]
    v_mfma_f32_32x32x16_bf16 v[220:235], v[60:63], v[148:151], v[220:235]
    ds_read_b64_tr_b16 v[56:57], v14 offset:6144
    ds_read_b64_tr_b16 v[58:59], v14 offset:7168
    ds_read_b64_tr_b16 v[60:61], v15 offset:6144
    ds_read_b64_tr_b16 v[62:63], v15 offset:7168
    s_waitcnt lgkmcnt(4)
    v_mfma_f32_32x32x16_bf16 v[204:219], v[48:51], v[152:155], v[204:219]
    v_mfma_f32_32x32x16_bf16 v[220:235], v[52:55], v[152:155], v[220:235]
    s_waitcnt lgkmcnt(0)
    v_mfma_f32_32x32x16_bf16 v[204:219], v[56:59], v[156:159], v[204:219]
    v_mfma_f32_32x32x16_bf16 v[220:235], v[60:63], v[156:159], v[220:235]
L_og_nm5:
    s_bitcmp1_b32 s54, 12
    s_cbranch_scc1 L_og_nm6
    s_bitcmp1_b32 s48, 12
    s_cbranch_scc0 L_og_next
    s_bitset1_b32 s54, 12
    s_add_u32 s53, s50, 6
    s_and_b32 s53, s53, 7
    s_lshl_b32 s53, s53, 13
    v_add_u32 v14, s53, v12
    v_add_u32 v15, s53, v13
    ds_read_b64_tr_b16 v[48:49], v14 offset:0
    ds_read_b64_tr_b16 v[50:51], v14 offset:1024
    ds_read_b64_tr_b16 v[52:53], v15 offset:0
    ds_read_b64_tr_b16 v[54:55], v15 offset:1024
    ds_read_b64_tr_b16 v[56:57], v14 offset:2048
    ds_read_b64_tr_b16 v[58:59], v14 offset:3072
    ds_read_b64_tr_b16 v[60:61], v15 offset:2048
    ds_read_b64_tr_b16 v[62:63], v15 offset:3072
    s_waitcnt lgkmcnt(4)
    v_mfma_f32_32x32x16_bf16 v[204:219], v[48:51], v[160:163], v[204:219]
    v_mfma_f32_32x32x16_bf16 v[220:235], v[52:55], v[160:163], v[220:235]
    ds_read_b64_tr_b16 v[48:49], v14 offset:4096
    ds_read_b64_tr_b16 v[50:51], v14 offset:5120
    ds_read_b64_tr_b16 v[52:53], v15 offset:4096
    ds_read_b64_tr_b16 v[54:55], v15 offset:5120
    s_waitcnt lgkmcnt(4)
    v_mfma_f32_32x32x16_bf16 v[204:219], v[56:59], v[164:167], v[204:219]
    v_mfma_f32_32x32x16_bf16 v[220:235], v[60:63], v[164:167], v[220:235]
    ds_read_b64_tr_b16 v[56:57], v14 offset:6144
    ds_read_b64_tr_b16 v[58:59], v14 offset:7168
    ds_read_b64_tr_b16 v[60:61], v15 offset:6144
    ds_read_b64_tr_b16 v[62:63], v15 offset:7168
    s_waitcnt lgkmcnt(4)
    v_mfma_f32_32x32x16_bf16 v[204:219], v[48:51], v[168:171], v[204:219]
    v_mfma_f32_32x32x16_bf16 v[220:235], v[52:55], v[168:171], v[220:235]
    s_waitcnt lgkmcnt(0)
    v_mfma_f32_32x32x16_bf16 v[204:219], v[56:59], v[172:175], v[204:219]
    v_mfma_f32_32x32x16_bf16 v[220:235], v[60:63], v[172:175], v[220:235]
L_og_nm6:
    s_bitcmp1_b32 s54, 14
    s_cbranch_scc1 L_og_nm7
    s_bitcmp1_b32 s48, 14
    s_cbranch_scc0 L_og_next
    s_bitset1_b32 s54, 14
    s_add_u32 s53, s50, 7
    s_and_b32 s53, s53, 7
    s_lshl_b32 s53, s53, 13
    v_add_u32 v14, s53, v12
    v_add_u32 v15, s53, v13
    ds_read_b64_tr_b16 v[48:49], v14 offset:0
    ds_read_b64_tr_b16 v[50:51], v14 offset:1024
    ds_read_b64_tr_b16 v[52:53], v15 offset:0
    ds_read_b64_tr_b16 v[54:55], v15 offset:1024
    ds_read_b64_tr_b16 v[56:57], v14 offset:2048
    ds_read_b64_tr_b16 v[58:59], v14 offset:3072
    ds_read_b64_tr_b16 v[60:61], v15 offset:2048
    ds_read_b64_tr_b16 v[62:63], v15 offset:3072
    s_waitcnt lgkmcnt(4)
    v_mfma_f32_32x32x16_bf16 v[204:219], v[48:51], v[176:179], v[204:219]
    v_mfma_f32_32x32x16_bf16 v[220:235], v[52:55], v[176:179], v[220:235]
    ds_read_b64_tr_b16 v[48:49], v14 offset:4096
    ds_read_b64_tr_b16 v[50:51], v14 offset:5120
    ds_read_b64_tr_b16 v[52:53], v15 offset:4096
    ds_read_b64_tr_b16 v[54:55], v15 offset:5120
    s_waitcnt lgkmcnt(4)
    v_mfma_f32_32x32x16_bf16 v[204:219], v[56:59], v[180:183], v[204:219]
    v_mfma_f32_32x32x16_bf16 v[220:235], v[60:63], v[180:183], v[220:235]
    ds_read_b64_tr_b16 v[56:57], v14 offset:6144
    ds_read_b64_tr_b16 v[58:59], v14 offset:7168
    ds_read_b64_tr_b16 v[60:61], v15 offset:6144
    ds_read_b64_tr_b16 v[62:63], v15 offset:7168
    s_waitcnt lgkmcnt(4)
    v_mfma_f32_32x32x16_bf16 v[204:219], v[48:51], v[184:187], v[204:219]
    v_mfma_f32_32x32x16_bf16 v[220:235], v[52:55], v[184:187], v[220:235]
    s_waitcnt lgkmcnt(0)
    v_mfma_f32_32x32x16_bf16 v[204:219], v[56:59], v[188:191], v[204:219]
    v_mfma_f32_32x32x16_bf16 v[220:235], v[60:63], v[188:191], v[220:235]
L_og_nm7:
    s_cmp_eq_u32 s54, 0x5555
    s_cbranch_scc1 L_og_done
L_og_next:
    s_cmp_eq_u32 s57, 0
    s_cbranch_scc1 L_og_round
    s_waitcnt vmcnt(0)
    s_mov_b32 s48, 0x5555
    s_branch L_og_pass
    s_branch L_og_done
L_og_fast:
    s_add_u32 s53, s50, 0
    s_and_b32 s53, s53, 7
    s_lshl_b32 s53, s53, 12
    s_add_u32 s53, s53, s36
    buffer_load_dwordx4 v[64:67], v3, s[24:27], s53 offen offset:0 sc1
    buffer_load_dwordx4 v[68:71], v3, s[24:27], s53 offen offset:1024 sc1
    buffer_load_dwordx4 v[72:75], v3, s[24:27], s53 offen offset:2048 sc1
    buffer_load_dwordx4 v[76:79], v3, s[24:27], s53 offen offset:3072 sc1
    s_add_u32 s53, s50, 1
    s_and_b32 s53, s53, 7
    s_lshl_b32 s53, s53, 12
    s_add_u32 s53, s53, s36
    buffer_load_dwordx4 v[80:83], v3, s[24:27], s53 offen offset:0 sc1
    buffer_load_dwordx4 v[84:87], v3, s[24:27], s53 offen offset:1024 sc1
    buffer_load_dwordx4 v[88:91], v3, s[24:27], s53 offen offset:2048 sc1
    buffer_load_dwordx4 v[92:95], v3, s[24:27], s53 offen offset:3072 sc1
    s_add_u32 s53, s50, 2
    s_and_b32 s53, s53, 7
    s_lshl_b32 s53, s53, 12
    s_add_u32 s53, s53, s36
    buffer_load_dwordx4 v[96:99], v3, s[24:27], s53 offen offset:0 sc1
    buffer_load_dwordx4 v[100:103], v3, s[24:27], s53 offen offset:1024 sc1
    buffer_load_dwordx4 v[104:107], v3, s[24:27], s53 offen offset:2048 sc1
    buffer_load_dwordx4 v[108:111], v3, s[24:27], s53 offen offset:3072 sc1
    s_add_u32 s53, s50, 3
    s_and_b32 s53, s53, 7
    s_lshl_b32 s53, s53, 12
    s_add_u32 s53, s53, s36
    buffer_load_dwordx4 v[112:115], v3, s[24:27], s53 offen offset:0 sc1
    buffer_load_dwordx4 v[116:119], v3, s[24:27], s53 offen offset:1024 sc1
    buffer_load_dwordx4 v[120:123], v3, s[24:27], s53 offen offset:2048 sc1
    buffer_load_dwordx4 v[124:127], v3, s[24:27], s53 offen offset:3072 sc1
    s_add_u32 s53, s50, 4
    s_and_b32 s53, s53, 7
    s_lshl_b32 s53, s53, 12
    s_add_u32 s53, s53, s36
    buffer_load_dwordx4 v[128:131], v3, s[24:27], s53 offen offset:0 sc1
    buffer_load_dwordx4 v[132:135], v3, s[24:27], s53 offen offset:1024 sc1
    buffer_load_dwordx4 v[136:139], v3, s[24:27], s53 offen offset:2048 sc1
    buffer_load_dwordx4 v[140:143], v3, s[24:27], s53 offen offset:3072 sc1
    s_add_u32 s53, s50, 5
    s_and_b32 s53, s53, 7
    s_lshl_b32 s53, s53, 12
    s_add_u32 s53, s53, s36
    buffer_load_dwordx4 v[144:147], v3, s[24:27], s53 offen offset:0 sc1
    buffer_load_dwordx4 v[148:151], v3, s[24:27], s53 offen offset:1024 sc1
    buffer_load_dwordx4 v[152:155], v3, s[24:27], s53 offen offset:2048 sc1
    buffer_load_dwordx4 v[156:159], v3, s[24:27], s53 offen offset:3072 sc1
    s_add_u32 s53, s50, 6
    s_and_b32 s53, s53, 7
    s_lshl_b32 s53, s53, 12
    s_add_u32 s53, s53, s36
    buffer_load_dwordx4 v[160:163], v3, s[24:27], s53 offen offset:0 sc1
    buffer_load_dwordx4 v[164:167], v3, s[24:27], s53 offen offset:1024 sc1
    buffer_load_dwordx4 v[168:171], v3, s[24:27], s53 offen offset:2048 sc1
    buffer_load_dwordx4 v[172:175], v3, s[24:27], s53 offen offset:3072 sc1
    s_add_u32 s53, s50, 7
    s_and_b32 s53, s53, 7
    s_lshl_b32 s53, s53, 12
    s_add_u32 s53, s53, s36
    buffer_load_dwordx4 v[176:179], v3, s[24:27], s53 offen offset:0 sc1
    buffer_load_dwordx4 v[180:183], v3, s[24:27], s53 offen offset:1024 sc1
    buffer_load_dwordx4 v[184:187], v3, s[24:27], s53 offen offset:2048 sc1
    buffer_load_dwordx4 v[188:191], v3, s[24:27], s53 offen offset:3072 sc1
    s_add_u32 s53, s50, 0
    s_and_b32 s53, s53, 7
    s_lshl_b32 s53, s53, 13
    v_add_u32 v14, s53, v12
    v_add_u32 v15, s53, v13
    ds_read_b64_tr_b16 v[48:49], v14 offset:0
    ds_read_b64_tr_b16 v[50:51], v14 offset:1024
    ds_read_b64_tr_b16 v[52:53], v15 offset:0
    ds_read_b64_tr_b16 v[54:55], v15 offset:1024
    ds_read_b64_tr_b16 v[56:57], v14 offset:2048
    ds_read_b64_tr_b16 v[58:59], v14 offset:3072
    ds_read_b64_tr_b16 v[60:61], v15 offset:2048
    ds_read_b64_tr_b16 v[62:63], v15 offset:3072
    s_waitcnt vmcnt(30) lgkmcnt(4)
    v_mfma_f32_32x32x16_bf16 v[16:31], v[48:51], v[64:67], v[16:31]
    v_mfma_f32_32x32x16_bf16 v[32:47], v[52:55], v[64:67], v[32:47]
    ds_read_b64_tr_b16 v[48:49], v14 offset:4096
    ds_read_b64_tr_b16 v[50:51], v14 offset:5120
    ds_read_b64_tr_b16 v[52:53], v15 offset:4096
    ds_read_b64_tr_b16 v[54:55], v15 offset:5120
    s_waitcnt lgkmcnt(4)
    v_mfma_f32_32x32x16_bf16 v[16:31], v[56:59], v[68:71], v[16:31]
    v_mfma_f32_32x32x16_bf16 v[32:47], v[60:63], v[68:71], v[32:47]
    ds_read_b64_tr_b16 v[56:57], v14 offset:6144
    ds_read_b64_tr_b16 v[58:59], v14 offset:7168
    ds_read_b64_tr_b16 v[60:61], v15 offset:6144
    ds_read_b64_tr_b16 v[62:63], v15 offset:7168
    s_waitcnt vmcnt(28) lgkmcnt(4)
    v_mfma_f32_32x32x16_bf16 v[16:31], v[48:51], v[72:75], v[16:31]
    v_mfma_f32_32x32x16_bf16 v[32:47], v[52:55], v[72:75], v[32:47]
    s_waitcnt lgkmcnt(0)
    v_mfma_f32_32x32x16_bf16 v[16:31], v[56:59], v[76:79], v[16:31]
    v_mfma_f32_32x32x16_bf16 v[32:47], v[60:63], v[76:79], v[32:47]
    s_add_u32 s53, s50, 1
    s_and_b32 s53, s53, 7
    s_lshl_b32 s53, s53, 13
    v_add_u32 v14, s53, v12
    v_add_u32 v15, s53, v13
    ds_read_b64_tr_b16 v[48:49], v14 offset:0
    ds_read_b64_tr_b16 v[50:51], v14 offset:1024
    ds_read_b64_tr_b16 v[52:53], v15 offset:0
    ds_read_b64_tr_b16 v[54:55], v15 offset:1024
    ds_read_b64_tr_b16 v[56:57], v14 offset:2048
    ds_read_b64_tr_b16 v[58:59], v14 offset:3072
    ds_read_b64_tr_b16 v[60:61], v15 offset:2048
    ds_read_b64_tr_b16 v[62:63], v15 offset:3072
    s_waitcnt vmcnt(26) lgkmcnt(4)
    v_mfma_f32_32x32x16_bf16 v[16:31], v[48:51], v[80:83], v[16:31]
    v_mfma_f32_32x32x16_bf16 v[32:47], v[52:55], v[80:83], v[32:47]
    ds_read_b64_tr_b16 v[48:49], v14 offset:4096
    ds_read_b64_tr_b16 v[50:51], v14 offset:5120
    ds_read_b64_tr_b16 v[52:53], v15 offset:4096
    ds_read_b64_tr_b16 v[54:55], v15 offset:5120
    s_waitcnt lgkmcnt(4)
    v_mfma_f32_32x32x16_bf16 v[16:31], v[56:59], v[84:87], v[16:31]
    v_mfma_f32_32x32x16_bf16 v[32:47], v[60:63], v[84:87], v[32:47]
    ds_read_b64_tr_b16 v[56:57], v14 offset:6144
    ds_read_b64_tr_b16 v[58:59], v14 offset:7168
    ds_read_b64_tr_b16 v[60:61], v15 offset:6144
    ds_read_b64_tr_b16 v[62:63], v15 offset:7168
    s_waitcnt vmcnt(24) lgkmcnt(4)
    v_mfma_f32_32x32x16_bf16 v[16:31], v[48:51], v[88:91], v[16:31]
    v_mfma_f32_32x32x16_bf16 v[32:47], v[52:55], v[88:91], v[32:47]
    s_waitcnt lgkmcnt(0)
    v_mfma_f32_32x32x16_bf16 v[16:31], v[56:59], v[92:95], v[16:31]
    v_mfma_f32_32x32x16_bf16 v[32:47], v[60:63], v[92:95], v[32:47]
    s_add_u32 s53, s50, 2
    s_and_b32 s53, s53, 7
    s_lshl_b32 s53, s53, 13
    v_add_u32 v14, s53, v12
    v_add_u32 v15, s53, v13
    ds_read_b64_tr_b16 v[48:49], v14 offset:0
    ds_read_b64_tr_b16 v[50:51], v14 offset:1024
    ds_read_b64_tr_b16 v[52:53], v15 offset:0
    ds_read_b64_tr_b16 v[54:55], v15 offset:1024
    ds_read_b64_tr_b16 v[56:57], v14 offset:2048
    ds_read_b64_tr_b16 v[58:59], v14 offset:3072
    ds_read_b64_tr_b16 v[60:61], v15 offset:2048
    ds_read_b64_tr_b16 v[62:63], v15 offset:3072
    s_waitcnt vmcnt(22) lgkmcnt(4)
    v_mfma_f32_32x32x16_bf16 v[16:31], v[48:51], v[96:99], v[16:31]
    v_mfma_f32_32x32x16_bf16 v[32:47], v[52:55], v[96:99], v[32:47]
    ds_read_b64_tr_b16 v[48:49], v14 offset:4096
    ds_read_b64_tr_b16 v[50:51], v14 offset:5120
    ds_read_b64_tr_b16 v[52:53], v15 offset:4096
    ds_read_b64_tr_b16 v[54:55], v15 offset:5120
    s_waitcnt lgkmcnt(4)
    v_mfma_f32_32x32x16_bf16 v[16:31], v[56:59], v[100:103], v[16:31]
    v_mfma_f32_32x32x16_bf16 v[32:47], v[60:63], v[100:103], v[32:47]
    ds_read_b64_tr_b16 v[56:57], v14 offset:6144
    ds_read_b64_tr_b16 v[58:59], v14 offset:7168
    ds_read_b64_tr_b16 v[60:61], v15 offset:6144
    ds_read_b64_tr_b16 v[62:63], v15 offset:7168
    s_waitcnt vmcnt(20) lgkmcnt(4)
    v_mfma_f32_32x32x16_bf16 v[16:31], v[48:51], v[104:107], v[16:31]
    v_mfma_f32_32x32x16_bf16 v[32:47], v[52:55], v[104:107], v[32:47]
    s_waitcnt lgkmcnt(0)
    v_mfma_f32_32x32x16_bf16 v[16:31], v[56:59], v[108:111], v[16:31]
    v_mfma_f32_32x32x16_bf16 v[32:47], v[60:63], v[108:111], v[32:47]
    s_add_u32 s53, s50, 3
    s_and_b32 s53, s53, 7
    s_lshl_b32 s53, s53, 13
    v_add_u32 v14, s53, v12
    v_add_u32 v15, s53, v13
    ds_read_b64_tr_b16 v[48:49], v14 offset:0
    ds_read_b64_tr_b16 v[50:51], v14 offset:1024
    ds_read_b64_tr_b16 v[52:53], v15 offset:0
    ds_read_b64_tr_b16 v[54:55], v15 offset:1024
    ds_read_b64_tr_b16 v[56:57], v14 offset:2048
    ds_read_b64_tr_b16 v[58:59], v14 offset:3072
    ds_read_b64_tr_b16 v[60:61], v15 offset:2048
    ds_read_b64_tr_b16 v[62:63], v15 offset:3072
    s_waitcnt vmcnt(18) lgkmcnt(4)
    v_mfma_f32_32x32x16_bf16 v[16:31], v[48:51], v[112:115], v[16:31]
    v_mfma_f32_32x32x16_bf16 v[32:47], v[52:55], v[112:115], v[32:47]
    ds_read_b64_tr_b16 v[48:49], v14 offset:4096
    ds_read_b64_tr_b16 v[50:51], v14 offset:5120
    ds_read_b64_tr_b16 v[52:53], v15 offset:4096
    ds_read_b64_tr_b16 v[54:55], v15 offset:5120
    s_waitcnt lgkmcnt(4)
    v_mfma_f32_32x32x16_bf16 v[16:31], v[56:59], v[116:119], v[16:31]
    v_mfma_f32_32x32x16_bf16 v[32:47], v[60:63], v[116:119], v[32:47]
    ds_read_b64_tr_b16 v[56:57], v14 offset:6144
    ds_read_b64_tr_b16 v[58:59], v14 offset:7168
    ds_read_b64_tr_b16 v[60:61], v15 offset:6144
    ds_read_b64_tr_b16 v[62:63], v15 offset:7168
    s_waitcnt vmcnt(16) lgkmcnt(4)
    v_mfma_f32_32x32x16_bf16 v[16:31], v[48:51], v[120:123], v[16:31]
    v_mfma_f32_32x32x16_bf16 v[32:47], v[52:55], v[120:123], v[32:47]
    s_waitcnt lgkmcnt(0)
    v_mfma_f32_32x32x16_bf16 v[16:31], v[56:59], v[124:127], v[16:31]
    v_mfma_f32_32x32x16_bf16 v[32:47], v[60:63], v[124:127], v[32:47]
    s_add_u32 s53, s50, 4
    s_and_b32 s53, s53, 7
    s_lshl_b32 s53, s53, 13
    v_add_u32 v14, s53, v12
    v_add_u32 v15, s53, v13
    ds_read_b64_tr_b16 v[48:49], v14 offset:0
    ds_read_b64_tr_b16 v[50:51], v14 offset:1024
    ds_read_b64_tr_b16 v[52:53], v15 offset:0
    ds_read_b64_tr_b16 v[54:55], v15 offset:1024
    ds_read_b64_tr_b16 v[56:57], v14 offset:2048
    ds_read_b64_tr_b16 v[58:59], v14 offset:3072
    ds_read_b64_tr_b16 v[60:61], v15 offset:2048
    ds_read_b64_tr_b16 v[62:63], v15 offset:3072
    s_waitcnt vmcnt(14) lgkmcnt(4)
    v_mfma_f32_32x32x16_bf16 v[204:219], v[48:51], v[128:131], v[204:219]
    v_mfma_f32_32x32x16_bf16 v[220:235], v[52:55], v[128:131], v[220:235]
    ds_read_b64_tr_b16 v[48:49], v14 offset:4096
    ds_read_b64_tr_b16 v[50:51], v14 offset:5120
    ds_read_b64_tr_b16 v[52:53], v15 offset:4096
    ds_read_b64_tr_b16 v[54:55], v15 offset:5120
    s_waitcnt lgkmcnt(4)
    v_mfma_f32_32x32x16_bf16 v[204:219], v[56:59], v[132:135], v[204:219]
    v_mfma_f32_32x32x16_bf16 v[220:235], v[60:63], v[132:135], v[220:235]
    ds_read_b64_tr_b16 v[56:57], v14 offset:6144
    ds_read_b64_tr_b16 v[58:59], v14 offset:7168
    ds_read_b64_tr_b16 v[60:61], v15 offset:6144
    ds_read_b64_tr_b16 v[62:63], v15 offset:7168
    s_waitcnt vmcnt(12) lgkmcnt(4)
    v_mfma_f32_32x32x16_bf16 v[204:219], v[48:51], v[136:139], v[204:219]
    v_mfma_f32_32x32x16_bf16 v[220:235], v[52:55], v[136:139], v[220:235]
    s_waitcnt lgkmcnt(0)
    v_mfma_f32_32x32x16_bf16 v[204:219], v[56:59], v[140:143], v[204:219]
    v_mfma_f32_32x32x16_bf16 v[220:235], v[60:63], v[140:143], v[220:235]
    s_add_u32 s53, s50, 5
    s_and_b32 s53, s53, 7
    s_lshl_b32 s53, s53, 13
    v_add_u32 v14, s53, v12
    v_add_u32 v15, s53, v13
    ds_read_b64_tr_b16 v[48:49], v14 offset:0
    ds_read_b64_tr_b16 v[50:51], v14 offset:1024
    ds_read_b64_tr_b16 v[52:53], v15 offset:0
    ds_read_b64_tr_b16 v[54:55], v15 offset:1024
    ds_read_b64_tr_b16 v[56:57], v14 offset:2048
    ds_read_b64_tr_b16 v[58:59], v14 offset:3072
    ds_read_b64_tr_b16 v[60:61], v15 offset:2048
    ds_read_b64_tr_b16 v[62:63], v15 offset:3072
    s_waitcnt vmcnt(10) lgkmcnt(4)
    v_mfma_f32_32x32x16_bf16 v[204:219], v[48:51], v[144:147], v[204:219]
    v_mfma_f32_32x32x16_bf16 v[220:235], v[52:55], v[144:147], v[220:235]
    ds_read_b64_tr_b16 v[48:49], v14 offset:4096
    ds_read_b64_tr_b16 v[50:51], v14 offset:5120
    ds_read_b64_tr_b16 v[52:53], v15 offset:4096
    ds_read_b64_tr_b16 v[54:55], v15 offset:5120
    s_waitcnt lgkmcnt(4)
    v_mfma_f32_32x32x16_bf16 v[204:219], v[56:59], v[148:151], v[204:219]
    v_mfma_f32_32x32x16_bf16 v[220:235], v[60:63], v[148:151], v[220:235]
    ds_read_b64_tr_b16 v[56:57], v14 offset:6144
    ds_read_b64_tr_b16 v[58:59], v14 offset:7168
    ds_read_b64_tr_b16 v[60:61], v15 offset:6144
    ds_read_b64_tr_b16 v[62:63], v15 offset:7168
    s_waitcnt vmcnt(8) lgkmcnt(4)
    v_mfma_f32_32x32x16_bf16 v[204:219], v[48:51], v[152:155], v[204:219]
    v_mfma_f32_32x32x16_bf16 v[220:235], v[52:55], v[152:155], v[220:235]
    s_waitcnt lgkmcnt(0)
    v_mfma_f32_32x32x16_bf16 v[204:219], v[56:59], v[156:159], v[204:219]
    v_mfma_f32_32x32x16_bf16 v[220:235], v[60:63], v[156:159], v[220:235]
    s_add_u32 s53, s50, 6
    s_and_b32 s53, s53, 7
    s_lshl_b32 s53, s53, 13
    v_add_u32 v14, s53, v12
    v_add_u32 v15, s53, v13
    ds_read_b64_tr_b16 v[48:49], v14 offset:0
    ds_read_b64_tr_b16 v[50:51], v14 offset:1024
    ds_read_b64_tr_b16 v[52:53], v15 offset:0
    ds_read_b64_tr_b16 v[54:55], v15 offset:1024
    ds_read_b64_tr_b16 v[56:57], v14 offset:2048
    ds_read_b64_tr_b16 v[58:59], v14 offset:3072
    ds_read_b64_tr_b16 v[60:61], v15 offset:2048
    ds_read_b64_tr_b16 v[62:63], v15 offset:3072
    s_waitcnt vmcnt(6) lgkmcnt(4)
    v_mfma_f32_32x32x16_bf16 v[204:219], v[48:51], v[160:163], v[204:219]
    v_mfma_f32_32x32x16_bf16 v[220:235], v[52:55], v[160:163], v[220:235]
    ds_read_b64_tr_b16 v[48:49], v14 offset:4096
    ds_read_b64_tr_b16 v[50:51], v14 offset:5120
    ds_read_b64_tr_b16 v[52:53], v15 offset:4096
    ds_read_b64_tr_b16 v[54:55], v15 offset:5120
    s_waitcnt lgkmcnt(4)
    v_mfma_f32_32x32x16_bf16 v[204:219], v[56:59], v[164:167], v[204:219]
    v_mfma_f32_32x32x16_bf16 v[220:235], v[60:63], v[164:167], v[220:235]
    ds_read_b64_tr_b16 v[56:57], v14 offset:6144
    ds_read_b64_tr_b16 v[58:59], v14 offset:7168
    ds_read_b64_tr_b16 v[60:61], v15 offset:6144
    ds_read_b64_tr_b16 v[62:63], v15 offset:7168
    s_waitcnt vmcnt(4) lgkmcnt(4)
    v_mfma_f32_32x32x16_bf16 v[204:219], v[48:51], v[168:171], v[204:219]
    v_mfma_f32_32x32x16_bf16 v[220:235], v[52:55], v[168:171], v[220:235]
    s_waitcnt lgkmcnt(0)
    v_mfma_f32_32x32x16_bf16 v[204:219], v[56:59], v[172:175], v[204:219]
    v_mfma_f32_32x32x16_bf16 v[220:235], v[60:63], v[172:175], v[220:235]
    s_add_u32 s53, s50, 7
    s_and_b32 s53, s53, 7
    s_lshl_b32 s53, s53, 13
    v_add_u32 v14, s53, v12
    v_add_u32 v15, s53, v13
    ds_read_b64_tr_b16 v[48:49], v14 offset:0
    ds_read_b64_tr_b16 v[50:51], v14 offset:1024
    ds_read_b64_tr_b16 v[52:53], v15 offset:0
    ds_read_b64_tr_b16 v[54:55], v15 offset:1024
    ds_read_b64_tr_b16 v[56:57], v14 offset:2048
    ds_read_b64_tr_b16 v[58:59], v14 offset:3072
    ds_read_b64_tr_b16 v[60:61], v15 offset:2048
    ds_read_b64_tr_b16 v[62:63], v15 offset:3072
    s_waitcnt vmcnt(2) lgkmcnt(4)
    v_mfma_f32_32x32x16_bf16 v[204:219], v[48:51], v[176:179], v[204:219]
    v_mfma_f32_32x32x16_bf16 v[220:235], v[52:55], v[176:179], v[220:235]
    ds_read_b64_tr_b16 v[48:49], v14 offset:4096
    ds_read_b64_tr_b16 v[50:51], v14 offset:5120
    ds_read_b64_tr_b16 v[52:53], v15 offset:4096
    ds_read_b64_tr_b16 v[54:55], v15 offset:5120
    s_waitcnt lgkmcnt(4)
    v_mfma_f32_32x32x16_bf16 v[204:219], v[56:59], v[180:183], v[204:219]
    v_mfma_f32_32x32x16_bf16 v[220:235], v[60:63], v[180:183], v[220:235]
    ds_read_b64_tr_b16 v[56:57], v14 offset:6144
    ds_read_b64_tr_b16 v[58:59], v14 offset:7168
    ds_read_b64_tr_b16 v[60:61], v15 offset:6144
    ds_read_b64_tr_b16 v[62:63], v15 offset:7168
    s_waitcnt vmcnt(0) lgkmcnt(4)
    v_mfma_f32_32x32x16_bf16 v[204:219], v[48:51], v[184:187], v[204:219]
    v_mfma_f32_32x32x16_bf16 v[220:235], v[52:55], v[184:187], v[220:235]
    s_waitcnt lgkmcnt(0)
    v_mfma_f32_32x32x16_bf16 v[204:219], v[56:59], v[188:191], v[204:219]
    v_mfma_f32_32x32x16_bf16 v[220:235], v[60:63], v[188:191], v[220:235]
L_og_done:
    s_nop 11
    s_nop 1
    v_add_f32 v16, v16, v204
    v_add_f32 v17, v17, v205
    v_add_f32 v18, v18, v206
    v_add_f32 v19, v19, v207
    v_add_f32 v20, v20, v208
    v_add_f32 v21, v21, v209
    v_add_f32 v22, v22, v210
    v_add_f32 v23, v23, v211
    v_add_f32 v24, v24, v212
    v_add_f32 v25, v25, v213
    v_add_f32 v26, v26, v214
    v_add_f32 v27, v27, v215
    v_add_f32 v28, v28, v216
    v_add_f32 v29, v29, v217
    v_add_f32 v30, v30, v218
    v_add_f32 v31, v31, v219
    v_add_f32 v32, v32, v220
    v_add_f32 v33, v33, v221
    v_add_f32 v34, v34, v222
    v_add_f32 v35, v35, v223
    v_add_f32 v36, v36, v224
    v_add_f32 v37, v37, v225
    v_add_f32 v38, v38, v226
    v_add_f32 v39, v39, v227
    v_add_f32 v40, v40, v228
    v_add_f32 v41, v41, v229
    v_add_f32 v42, v42, v230
    v_add_f32 v43, v43, v231
    v_add_f32 v44, v44, v232
    v_add_f32 v45, v45, v233
    v_add_f32 v46, v46, v234
    v_add_f32 v47, v47, v235
    s_cmp_eq_u32 s15, 0
    s_cbranch_scc1 L_op_kh0
    ds_write_b128 v196, v[16:19] offset:0
    ds_write_b128 v196, v[20:23] offset:1024
    ds_write_b128 v196, v[24:27] offset:2048
    ds_write_b128 v196, v[28:31] offset:3072
    v_mov_b32 v48, v32
    v_mov_b32 v49, v33
    v_mov_b32 v50, v34
    v_mov_b32 v51, v35
    v_mov_b32 v52, v36
    v_mov_b32 v53, v37
    v_mov_b32 v54, v38
    v_mov_b32 v55, v39
    v_mov_b32 v56, v40
    v_mov_b32 v57, v41
    v_mov_b32 v58, v42
    v_mov_b32 v59, v43
    v_mov_b32 v60, v44
    v_mov_b32 v61, v45
    v_mov_b32 v62, v46
    v_mov_b32 v63, v47
    s_branch L_op_x
L_op_kh0:
    ds_write_b128 v196, v[32:35] offset:0
    ds_write_b128 v196, v[36:39] offset:1024
    ds_write_b128 v196, v[40:43] offset:2048
    ds_write_b128 v196, v[44:47] offset:3072
    v_mov_b32 v48, v16
    v_mov_b32 v49, v17
    v_mov_b32 v50, v18
    v_mov_b32 v51, v19
    v_mov_b32 v52, v20
    v_mov_b32 v53, v21
    v_mov_b32 v54, v22
    v_mov_b32 v55, v23
    v_mov_b32 v56, v24
    v_mov_b32 v57, v25
    v_mov_b32 v58, v26
    v_mov_b32 v59, v27
    v_mov_b32 v60, v28
    v_mov_b32 v61, v29
    v_mov_b32 v62, v30
    v_mov_b32 v63, v31
L_op_x:
    s_mov_b32 s47, 0
L_op_spin:
    ds_read_b128 v[76:79], v197 offset:3072
    s_add_u32 s47, s47, 1
    s_waitcnt lgkmcnt(0)
    v_cmp_eq_u32 vcc, -1, v76
    s_cmp_ge_u32 s47, 640000
    s_cbranch_scc1 L_op_go
    s_cmp_eq_u64 vcc, 0
    s_cbranch_scc0 L_op_spin
L_op_go:
    ds_read_b128 v[64:67], v197 offset:0
    ds_read_b128 v[68:71], v197 offset:1024
    ds_read_b128 v[72:75], v197 offset:2048
    s_waitcnt lgkmcnt(0)
    v_add_f32 v48, v48, v64
    v_add_f32 v49, v49, v65
    v_add_f32 v50, v50, v66
    v_add_f32 v51, v51, v67
    v_add_f32 v52, v52, v68
    v_add_f32 v53, v53, v69
    v_add_f32 v54, v54, v70
    v_add_f32 v55, v55, v71
    v_add_f32 v56, v56, v72
    v_add_f32 v57, v57, v73
    v_add_f32 v58, v58, v74
    v_add_f32 v59, v59, v75
    v_add_f32 v60, v60, v76
    v_add_f32 v61, v61, v77
    v_add_f32 v62, v62, v78
    v_add_f32 v63, v63, v79
    v_cvt_pk_bf16_f32 v64, v48, v49
    v_cvt_pk_bf16_f32 v65, v50, v51
    v_cvt_pk_bf16_f32 v66, v52, v53
    v_cvt_pk_bf16_f32 v67, v54, v55
    v_cvt_pk_bf16_f32 v68, v56, v57
    v_cvt_pk_bf16_f32 v69, v58, v59
    v_cvt_pk_bf16_f32 v70, v60, v61
    v_cvt_pk_bf16_f32 v71, v62, v63
    v_and_b32 v5, 31, v2
    v_lshlrev_b32 v5, 11, v5
    v_lshrrev_b32 v6, 5, v2
    v_lshlrev_b32 v6, 4, v6
    v_add_u32 v5, v5, v6
    v_permlane32_swap_b32 v64, v66
    v_permlane32_swap_b32 v65, v67
    v_permlane32_swap_b32 v68, v70
    v_permlane32_swap_b32 v69, v71
    s_lshl_b32 s36, s10, 2
    s_add_u32 s36, s36, s16
    s_lshl_b32 s36, s36, 16
    s_lshl_b32 s37, s11, 7
    s_add_u32 s36, s36, s37
    s_lshl_b32 s37, s15, 6
    s_add_u32 s36, s36, s37
    buffer_store_dwordx4 v[64:67], v5, s[32:35], s36 offen
    buffer_store_dwordx4 v[68:71], v5, s[32:35], s36 offen offset:32
    s_endpgm
L_qpf_out:
    s_cmp_eq_u32 s14, 3
    s_cbranch_scc1 L_qpf_xc
    s_cmp_eq_u32 s14, 0
    s_cbranch_scc0 L_qpf_donec
    global_load_dword v16, v14, s[6:7]
    v_add_u32 v14, 1572864, v14
    s_branch L_qpf_donec
L_qpf_xc:
    global_load_dwordx4 v[16:19], v14, s[4:5]
    v_add_u32 v13, 4096, v14
    global_load_dwordx4 v[16:19], v15, s[4:5]
    global_load_dwordx4 v[16:19], v13, s[4:5]
    v_add_u32 v13, 4096, v15
    v_add_u32 v14, 512, v14
    global_load_dwordx4 v[16:19], v13, s[4:5]
    v_add_u32 v15, 512, v15
L_qpf_donec:
    s_branch L_qpf_back
L_flag_out:
    s_waitcnt vmcnt(0)
    s_lshl_b32 s36, s10, 13
    s_lshl_b32 s39, s11, 9
    s_add_u32 s36, s36, s39
    s_lshl_b32 s39, s14, 7
    s_add_u32 s36, s36, s39
    s_add_u32 s36, s36, 12582912
    v_mov_b32 v4, s36
    v_mov_b32 v5, s46
    s_mov_b64 exec, 1
    buffer_store_dword v5, v4, s[24:27], 0 offen sc1
    s_mov_b64 exec, -1
    s_branch L_flag_back
L_at_slow:
    v_mov_b32 v107, 0xff800000
    v_mov_b32 v96, 0
    v_mov_b32 v80, 0
    v_mov_b32 v81, 0
    v_mov_b32 v82, 0
    v_mov_b32 v83, 0
    v_mov_b32 v84, 0
    v_mov_b32 v85, 0
    v_mov_b32 v86, 0
    v_mov_b32 v87, 0
    v_mov_b32 v88, 0
    v_mov_b32 v89, 0
    v_mov_b32 v90, 0
    v_mov_b32 v91, 0
    v_mov_b32 v92, 0
    v_mov_b32 v93, 0
    v_mov_b32 v94, 0
    v_mov_b32 v95, 0
    s_lshl_b32 s36, s17, 18
    s_mov_b32 s47, 0
L_at_slow_loop:
    buffer_load_dwordx4 v[16:19], v3, s[24:27], s36 offen sc1
    buffer_load_dwordx4 v[20:23], v3, s[24:27], s36 offen offset:1024 sc1
    buffer_load_dwordx4 v[24:27], v3, s[24:27], s36 offen offset:2048 sc1
    buffer_load_dwordx4 v[28:31], v3, s[24:27], s36 offen offset:3072 sc1
    s_waitcnt vmcnt(0)
    v_mfma_f32_32x32x16_bf16 v[32:47], v[16:19], v[8:11], 0
    v_mfma_f32_32x32x16_bf16 v[32:47], v[20:23], v[12:15], v[32:47]
    s_nop 15
    s_nop 3
    v_max_f32 v4, v32, v33
    v_max_f32 v4, v4, v34
    v_max_f32 v4, v4, v35
    v_max_f32 v4, v4, v36
    v_max_f32 v4, v4, v37
    v_max_f32 v4, v4, v38
    v_max_f32 v4, v4, v39
    v_max_f32 v4, v4, v40
    v_max_f32 v4, v4, v41
    v_max_f32 v4, v4, v42
    v_max_f32 v4, v4, v43
    v_max_f32 v4, v4, v44
    v_max_f32 v4, v4, v45
    v_max_f32 v4, v4, v46
    v_max_f32 v4, v4, v47
    v_mov_b32 v5, v4
    s_nop 1
    v_permlane32_swap_b32 v4, v5
    s_nop 1
    v_max_f32 v4, v4, v5
    v_max_f32 v4, v4, v107
    v_sub_f32 v5, v107, v4
    v_exp_f32 v5, v5
    v_mov_b32 v107, v4
    v_sub_f32 v32, v32, v4
    v_sub_f32 v33, v33, v4
    v_sub_f32 v34, v34, v4
    v_sub_f32 v35, v35, v4
    v_sub_f32 v36, v36, v4
    v_sub_f32 v37, v37, v4
    v_sub_f32 v38, v38, v4
    v_sub_f32 v39, v39, v4
    v_sub_f32 v40, v40, v4
    v_sub_f32 v41, v41, v4
    v_sub_f32 v42, v42, v4
    v_sub_f32 v43, v43, v4
    v_sub_f32 v44, v44, v4
    v_sub_f32 v45, v45, v4
    v_sub_f32 v46, v46, v4
    v_sub_f32 v47, v47, v4
    v_exp_f32 v32, v32
    v_exp_f32 v33, v33
    v_exp_f32 v34, v34
    v_exp_f32 v35, v35
    v_exp_f32 v36, v36
    v_exp_f32 v37, v37
    v_exp_f32 v38, v38
    v_exp_f32 v39, v39
    v_exp_f32 v40, v40
    v_exp_f32 v41, v41
    v_exp_f32 v42, v42
    v_exp_f32 v43, v43
    v_exp_f32 v44, v44
    v_exp_f32 v45, v45
    v_exp_f32 v46, v46
    v_exp_f32 v47, v47
    s_nop 0
    v_cvt_pk_bf16_f32 v64, v32, v33
    v_cvt_pk_bf16_f32 v65, v34, v35
    v_cvt_pk_bf16_f32 v66, v36, v37
    v_cvt_pk_bf16_f32 v67, v38, v39
    v_cvt_pk_bf16_f32 v68, v40, v41
    v_cvt_pk_bf16_f32 v69, v42, v43
    v_cvt_pk_bf16_f32 v70, v44, v45
    v_cvt_pk_bf16_f32 v71, v46, v47
    v_mul_f32 v96, v96, v5
    v_mul_f32 v80, v80, v5
    v_mul_f32 v81, v81, v5
    v_mul_f32 v82, v82, v5
    v_mul_f32 v83, v83, v5
    v_mul_f32 v84, v84, v5
    v_mul_f32 v85, v85, v5
    v_mul_f32 v86, v86, v5
    v_mul_f32 v87, v87, v5
    v_mul_f32 v88, v88, v5
    v_mul_f32 v89, v89, v5
    v_mul_f32 v90, v90, v5
    v_mul_f32 v91, v91, v5
    v_mul_f32 v92, v92, v5
    v_mul_f32 v93, v93, v5
    v_mul_f32 v94, v94, v5
    v_mul_f32 v95, v95, v5
    v_lshlrev_b32 v6, 16, v64
    v_and_b32 v7, 0xffff0000, v64
    v_add_f32 v96, v96, v6
    v_add_f32 v96, v96, v7
    v_lshlrev_b32 v6, 16, v65
    v_and_b32 v7, 0xffff0000, v65
    v_add_f32 v96, v96, v6
    v_add_f32 v96, v96, v7
    v_lshlrev_b32 v6, 16, v66
    v_and_b32 v7, 0xffff0000, v66
    v_add_f32 v96, v96, v6
    v_add_f32 v96, v96, v7
    v_lshlrev_b32 v6, 16, v67
    v_and_b32 v7, 0xffff0000, v67
    v_add_f32 v96, v96, v6
    v_add_f32 v96, v96, v7
    v_lshlrev_b32 v6, 16, v68
    v_and_b32 v7, 0xffff0000, v68
    v_add_f32 v96, v96, v6
    v_add_f32 v96, v96, v7
    v_lshlrev_b32 v6, 16, v69
    v_and_b32 v7, 0xffff0000, v69
    v_add_f32 v96, v96, v6
    v_add_f32 v96, v96, v7
    v_lshlrev_b32 v6, 16, v70
    v_and_b32 v7, 0xffff0000, v70
    v_add_f32 v96, v96, v6
    v_add_f32 v96, v96, v7
    v_lshlrev_b32 v6, 16, v71
    v_and_b32 v7, 0xffff0000, v71
    v_add_f32 v96, v96, v6
    v_add_f32 v96, v96, v7
    s_nop 1
    v_mfma_f32_32x32x16_bf16 v[80:95], v[24:27], v[64:67], v[80:95]
    v_mfma_f32_32x32x16_bf16 v[80:95], v[28:31], v[68:71], v[80:95]
    s_nop 15
    s_nop 3
    s_add_u32 s36, s36, 4096
    s_add_u32 s47, s47, 1
    s_cmp_lt_u32 s47, 64
    s_cbranch_scc1 L_at_slow_loop
    v_mov_b32 v5, v96
    v_mov_b32 v4, v96
    s_nop 1
    v_permlane32_swap_b32 v4, v5
    s_nop 1
    v_add_f32 v96, v4, v5
    s_branch L_at_fin
L_end:
    s_endpgm
.section .rodata,"a"
.p2align 6
.amdhsa_kernel standalone__softmax_full_mha__prompt_kernel
  .amdhsa_next_free_vgpr 244
  .amdhsa_next_free_sgpr 64
  .amdhsa_accum_offset 244
  .amdhsa_group_segment_fixed_size 0
  .amdhsa_kernarg_size 48
  .amdhsa_user_sgpr_count 2
  .amdhsa_user_sgpr_kernarg_segment_ptr 1
  .amdhsa_system_sgpr_workgroup_id_x 1
.end_amdhsa_kernel
```
